```python
import torch

def _softmax(x, axis=-1):
    return torch.softmax(x, dim=axis)
def _gelu(x):
    return torch.nn.functional.gelu(x, approximate="tanh")
def _silu(x):
    return torch.nn.functional.silu(x)
def _sigmoid(x):
    return torch.sigmoid(x)
def _layernorm(x, axis=-1, eps=1e-5):
    m = x.mean(dim=axis, keepdim=True)
    v = x.var(dim=axis, keepdim=True, unbiased=False)
    return (x - m) / torch.sqrt(v + eps)
def _scatter_add(tgt, idx, src, axis=0):
    return tgt.clone().index_add_(axis, idx, src)
def _segment_sum(src, seg, n):
    out = torch.zeros((n,) + src.shape[1:], dtype=src.dtype)
    return out.index_add_(0, seg, src)
def _pad(x, pw):
    flat = tuple(v for pair in reversed(pw) for v in pair)
    return torch.nn.functional.pad(x, flat)

kernel_name = 'gated_mix__ssm_conv_s5__linear_kernel_hedgehog__prompt'

def setup_inputs():

    _w = (lambda a: (lambda t: t.to(torch.bfloat16) if t.is_floating_point() else t)(torch.as_tensor(a)))
    def _A_setup():
        B, S, D = 1, 2048, 512
        P = D
        Lambda_re = -0.5 * (lambda _x: torch.exp(torch.as_tensor(_x)))((lambda *s: torch.randn(*s, dtype=torch.bfloat16) * 0.8)(P))
        Lambda_im = (lambda *s: torch.randn(*s, dtype=torch.bfloat16) * 0.8)(P) * 1.0
        B_re = (lambda *s: torch.randn(*s, dtype=torch.bfloat16) * 0.8)(P, D) * (D ** -0.5)
        B_im = (lambda *s: torch.randn(*s, dtype=torch.bfloat16) * 0.8)(P, D) * (D ** -0.5)
        C_re = (lambda *s: torch.randn(*s, dtype=torch.bfloat16) * 0.8)(D, P) * (P ** -0.5)
        C_im = (lambda *s: torch.randn(*s, dtype=torch.bfloat16) * 0.8)(D, P) * (P ** -0.5)
        log_dt = (lambda *s: torch.randn(*s, dtype=torch.bfloat16) * 0.8)(P) * 0.3 - 2.0
        Dskip = (lambda *s: torch.randn(*s, dtype=torch.bfloat16) * 0.8)(D)
        return {
            "x": _w((lambda *s: torch.randn(*s, dtype=torch.bfloat16) * 0.05)(B, S, D)),
            "Lambda_re": _w(Lambda_re),
            "Lambda_im": _w(Lambda_im),
            "B_re": _w(B_re),
            "B_im": _w(B_im),
            "C_re": _w(C_re),
            "C_im": _w(C_im),
            "log_dt": _w(log_dt),
            "Dskip": _w(Dskip),
        }
    _A_in = _A_setup()

    def _B_setup():
        B, S, D, H = 1, 2048, 512, 32
        Dh = D // H
        return {
            "x": _w((lambda *s: torch.randn(*s, dtype=torch.bfloat16) * 0.05)(B, S, D)),
            "wqkv": _w((lambda *s: torch.randn(*s, dtype=torch.bfloat16) * 1.6)(D, 3 * D)),
            "w_phi": _w((lambda *s: torch.randn(*s, dtype=torch.bfloat16) * 1.6)(H, Dh, Dh) * (Dh ** -0.5)),
            "wo": _w((lambda *s: torch.randn(*s, dtype=torch.bfloat16) * 0.05)(D, D)),
        }
    _B_in = _B_setup()

    return {
        "A_x": _A_in["x"],
        "A_Lambda_re": _A_in["Lambda_re"],
        "A_Lambda_im": _A_in["Lambda_im"],
        "A_B_re": _A_in["B_re"],
        "A_B_im": _A_in["B_im"],
        "A_C_re": _A_in["C_re"],
        "A_C_im": _A_in["C_im"],
        "A_log_dt": _A_in["log_dt"],
        "A_Dskip": _A_in["Dskip"],
        "B_x": _B_in["x"],
        "B_wqkv": _B_in["wqkv"],
        "B_w_phi": _B_in["w_phi"],
        "B_wo": _B_in["wo"],
        "gate_w": _w((lambda *s: torch.randn(*s, dtype=torch.bfloat16) * 0.05)(512) * 16.0),
    }

def reference(A_x, A_Lambda_re, A_Lambda_im, A_B_re, A_B_im, A_C_re, A_C_im, A_log_dt, A_Dskip, B_x, B_wqkv, B_w_phi, B_wo, gate_w):
    def _A_ref(x, Lambda_re, Lambda_im, B_re, B_im, C_re, C_im, log_dt, Dskip):
        Bsz, L, H = x.shape
        Lam = Lambda_re + 1j * Lambda_im
        Bmat = B_re + 1j * B_im
        Cmat = C_re + 1j * C_im
        dt = torch.exp(log_dt)
        Lam_bar = torch.exp(dt * Lam)
        B_bar = ((Lam_bar - 1.0) / Lam)[:, None] * Bmat
        Bu = torch.einsum("bld,pd->blp", x + 0j, B_bar)
        h = torch.zeros_like(Bu[:, 0, :])
        hs = []
        for t in range(L):
            h = Lam_bar[None, :] * h + Bu[:, t, :]
            hs.append(h)
        hseq = torch.stack(hs, 1)
        y = 2.0 * torch.einsum("blp,dp->bld", hseq, Cmat).real + x * Dskip[None, None, :]
        return y

    def _B_ref(x, wqkv, w_phi, wo):
        B, S, D = x.shape
        H = 32; Dh = D // H
        qkv = (lambda x, *d: x.permute(*d))((x @ wqkv).reshape(B, S, 3, H, Dh), 2, 0, 3, 1, 4)
        q, k, v = qkv[0], qkv[1], qkv[2]
        pq = torch.einsum("bhsd,hdf->bhsf", q, w_phi)
        pk = torch.einsum("bhsd,hdf->bhsf", k, w_phi)
        phi_q = torch.concatenate([_softmax(pq, axis=-1), _softmax(-pq, axis=-1)], axis=-1)
        phi_k = torch.concatenate([_softmax(pk, axis=-1), _softmax(-pk, axis=-1)], axis=-1)
        kv = torch.einsum("bhsf,bhsd->bhfd", phi_k, v)
        z  = torch.einsum("bhsf->bhf", phi_k)
        num = torch.einsum("bhqf,bhfd->bhqd", phi_q, kv)
        den = torch.einsum("bhqf,bhf->bhq", phi_q, z)[..., None] + 1e-6
        o = num / den
        return (lambda x, *d: x.permute(*d))(o, 0, 2, 1, 3).reshape(B, S, D) @ wo

    x = A_x
    g = _sigmoid((x * gate_w).sum(-1, keepdims=True))
    a = _A_ref(x, A_Lambda_re, A_Lambda_im, A_B_re, A_B_im, A_C_re, A_C_im, A_log_dt, A_Dskip)
    b = _B_ref(x, B_wqkv, B_w_phi, B_wo)
    return g * a + (1 - g) * b
```

```asm
; @launch grid=(256,1,1) block=(512,1,1) lds=163840
.amdgcn_target "amdgcn-amd-amdhsa--gfx950"
.text
.globl gated_mix__ssm_conv_s5__linear_kernel_hedgehog__prompt_kernel
.p2align 8
.type gated_mix__ssm_conv_s5__linear_kernel_hedgehog__prompt_kernel,@function
gated_mix__ssm_conv_s5__linear_kernel_hedgehog__prompt_kernel:
L_start:
    s_cmp_ge_u32 s2, 256
    s_cbranch_scc1 L_end
    s_load_dwordx16 s[4:19], s[0:1], 0
    s_load_dwordx16 s[20:35], s[0:1], 64
    s_load_dwordx2 s[36:37], s[0:1], 128
    v_lshrrev_b32 v1, 6, v0
    v_and_b32 v0, 63, v0
    v_readfirstlane_b32 s3, v1
    s_and_b32 s85, s2, 1
    s_bfe_u32 s77, s2, 0x30003
    s_lshl_b32 s85, s85, 3
    s_add_u32 s77, s85, s77
    s_and_b32 s85, s2, 6
    s_lshr_b32 s78, s2, 7
    s_add_u32 s78, s85, s78
    s_bfe_u32 s93, s2, 0x10006
    s_and_b32 s76, s3, 3
    s_and_b32 s86, s3, 1
    s_bfe_u32 s87, s3, 0x10001
    s_cmp_ge_u32 s3, 4
    s_cbranch_scc0 L_Q
    s_getpc_b64 s[44:45]
L_pc:
    s_lshr_b32 s85, s2, 3
    s_lshl_b32 s85, s85, 2
    s_add_u32 s85, s85, s76
    s_mul_i32 s85, s85, 384
    v_lshl_add_u32 v1, v0, 7, s85
    v_min_u32 v1, L_end-L_pc, v1
    s_mov_b64 exec, 7
    global_load_dword v1, v1, s[44:45]
    s_mov_b64 exec, -1
    v_lshlrev_b32 v6, 4, v0
    v_and_b32 v7, 31, v0
    v_lshrrev_b32 v8, 5, v0
    s_cmp_lg_u32 s93, 0
    s_cbranch_scc1 L_eS
    s_waitcnt lgkmcnt(0)
    s_mov_b32 s85, 0x6f0000
    s_load_dword s0, s[36:37], s85
    s_branch L_MKV
L_eS:
    v_and_b32 v2, 0x13, v0
    v_and_b32_e64 v3, 4, v0
    v_lshl_add_u32 v2, v3, 1, v2
    v_bfe_u32 v3, v0, 3, 1
    v_lshl_add_u32 v4, v3, 2, v2
    s_lshl_b32 s85, s78, 7
    s_lshl_b32 s3, s86, 6
    s_add_u32 s85, s85, s3
    v_lshl_add_u32 v2, v4, 1, s85
    s_waitcnt lgkmcnt(0)
    s_mov_b32 s85, 0x6f0000
    s_load_dword s0, s[36:37], s85
    global_load_ushort v18, v2, s[6:7]
    global_load_ushort v19, v2, s[8:9]
    global_load_ushort v20, v2, s[18:19]
    s_branch L_MS
.p2align 3
L_Q:
    v_lshrrev_b32 v3, 4, v0
    v_and_b32 v2, 7, v0
    v_xor_b32 v1, v2, v3
    v_lshlrev_b32 v1, 4, v1
    v_and_b32 v3, 32, v0
    v_lshlrev_b32 v3, 9, v3
    v_and_b32_e64 v4, 8, v0
    v_lshl_add_u32 v4, v4, 10, v3
    v_and_b32_e64 v5, 16, v0
    v_lshl_add_u32 v4, v5, 6, v4
    v_add_u32 v6, v4, v1
    v_xor_b32 v7, 64, v6
    v_add_u32 v8, 2048, v6
    v_add_u32 v9, 3072, v7
    v_add_u32 v7, 1024, v7
    v_lshrrev_b32 v14, 3, v0
    v_lshlrev_b32 v5, 2, v5
    v_lshlrev_b32 v2, 4, v2
    v_xor_b32 v15, v2, v5
    v_lshrrev_b32 v3, 1, v3
    v_and_b32 v4, 3, v14
    v_lshl_add_u32 v3, v4, 10, v3
    v_add_u32_e64 v3, v3, v1
    v_mul_u32_u24 v4, 3072, v14
    v_add_u32 v4, v4, v15
    s_and_b32 s85, s2, 1
    s_lshl_b32 s85, s85, 2
    s_and_b32 s79, s2, 6
    s_xor_b32 s79, s79, s85
    s_lshl_b32 s82, s77, 17
    s_lshl_b32 s85, s76, 15
    s_add_u32 s82, s82, s85
    s_lshl_b32 s92, s76, 12
    s_lshl_b32 s83, s78, 16
    s_lshl_b32 s85, s86, 15
    s_add_u32 s83, s83, s85
    s_mul_i32 s84, s86, 98304
    s_lshl_b32 s85, s87, 10
    s_add_u32 s84, s84, s85
    s_lshl_b32 s85, s78, 7
    s_add_u32 s84, s84, s85
    s_add_u32 s84, s84, 1024
    s_mov_b32 s38, 196608
    s_mov_b32 s46, 0x180000
    s_cmp_lg_u32 s93, 0
    s_cselect_b64 s[94:95], -1, 0
    s_cselect_b32 s83, s83, s84
    s_cselect_b32 s80, 128, s38
    s_cselect_b32 s46, 0x80000, s46
    s_cselect_b32 s85, 64, 0
    v_cndmask_b32 v10, v4, v3, s[94:95]
    v_xor_b32 v3, s85, v10
    s_cselect_b32 s85, 3, 23
    v_lshl_add_u32 v11, s85, 10, v3
    s_cselect_b32 s85, 14, 46
    v_lshl_add_u32 v12, s85, 10, v10
    s_cselect_b32 s85, 17, 69
    v_lshl_add_u32 v13, s85, 10, v3
    s_mov_b32 s42, 0x200000
    s_mov_b32 s43, 0x20000
    s_mov_b32 s47, 0x20000
    s_waitcnt lgkmcnt(0)
    s_mov_b64 s[40:41], s[4:5]
    s_cmp_lg_u32 s87, 0
    s_cselect_b64 s[44:45], s[12:13], s[10:11]
    s_cmp_lg_u32 s93, 0
    s_cselect_b64 s[44:45], s[44:45], s[24:25]
    s_mov_b32 s89, s80
    s_add_u32 s3, s79, 0
    s_and_b32 s3, s3, 7
    s_lshl_b32 s22, s3, 7
    s_add_u32 s22, s82, s22
    s_add_u32 m0, s92, 0
    s_mul_i32 s23, s3, s89
    buffer_load_dwordx4 v6, s[40:43], s22 offen offset:0 lds
    buffer_load_dwordx4 v7, s[40:43], s22 offen offset:1024 lds
    buffer_load_dwordx4 v8, s[40:43], s22 offen offset:2048 lds
    buffer_load_dwordx4 v9, s[40:43], s22 offen offset:3072 lds
    s_add_u32 m0, s92, 49152
    s_add_u32 s23, s83, s23
    buffer_load_dwordx4 v10, s[44:47], s23 offen offset:0 lds
    buffer_load_dwordx4 v11, s[44:47], s23 offen offset:1024 lds
    buffer_load_dwordx4 v12, s[44:47], s23 offen offset:2048 lds
    buffer_load_dwordx4 v13, s[44:47], s23 offen offset:3072 lds
    s_mov_b32 s85, 0x6f0000
    s_load_dword s0, s[36:37], s85
    v_lshlrev_b32 v16, 4, v0
    v_and_b32 v17, 31, v0
    v_lshrrev_b32 v18, 5, v0
    s_mov_b64 s[64:65], s[36:37]
    s_mov_b32 s66, 0x6f1000
    s_mov_b32 s67, 0x20000
    s_mov_b32 s90, 0x3fb8aa3b
    s_mov_b32 s91, 0x3fb8aa3b
    s_mov_b32 s88, 200000
    s_mov_b32 s34, 0xffff
    s_mov_b32 s35, 0xffff
    v_mov_b32 v19, 133120
    v_lshl_add_u32 v20, s76, 2, v19
    v_mov_b32 v21, 0
    s_mul_i32 s39, s87, 49152
    s_lshl_b32 s85, s86, 13
    s_add_u32 s39, s39, s85
    s_lshl_b32 s85, s77, 1
    s_add_u32 s85, s85, s87
    s_mul_i32 s38, s85, 196608
    s_mul_i32 s85, s78, 12288
    s_add_u32 s38, s38, s85
    s_lshl_b32 s85, s78, 11
    s_lshl_b32 s3, s86, 10
    s_add_u32 s85, s85, s3
    s_mov_b32 s54, 0x4000
    s_cmp_lg_u32 s87, 0
    s_cselect_b64 s[52:53], s[30:31], s[26:27]
    s_cselect_b32 s54, 1024, s54
    s_cselect_b32 s85, s3, s85
    s_cselect_b32 s84, s79, 0
    s_mov_b32 s55, 0x20000
    v_lshl_add_u32 v2, s84, 7, v16
    v_and_b32 v2, 1023, v2
    s_lshl_b32 s84, s87, 12
    s_add_u32 s3, s3, s84
    s_add_u32 m0, s3, 131072
    s_nop 0
    buffer_load_dwordx4 v2, s[52:55], s85 offen lds
    s_add_u32 s3, s79, 1
    s_and_b32 s3, s3, 7
    s_lshl_b32 s22, s3, 7
    s_add_u32 s22, s82, s22
    s_add_u32 m0, s92, 16384
    s_mul_i32 s23, s3, s89
    buffer_load_dwordx4 v6, s[40:43], s22 offen offset:0 lds
    buffer_load_dwordx4 v7, s[40:43], s22 offen offset:1024 lds
    s_and_b32 s85, s2, 7
    s_bfe_u32 s3, s2, 0x20003
    s_lshl_b32 s85, s85, 2
    s_add_u32 s80, s85, s3
    s_lshr_b32 s81, s2, 5
    v_bfe_u32 v2, v0, 1, 3
    v_xor_b32 v2, v2, v18
    v_lshlrev_b32 v2, 4, v2
    v_lshl_add_u32 v2, v17, 7, v2
    v_xor_b32 v3, 0, v2
    v_add_u32 v22, s92, v3
    v_xor_b32 v3, 32, v2
    v_add_u32 v23, s92, v3
    v_xor_b32 v3, 64, v2
    v_add_u32 v24, s92, v3
    v_xor_b32 v3, 96, v2
    v_add_u32_e64 v25, s92, v3
    v_bfe_u32 v2, v0, 2, 2
    v_lshl_add_u32 v3, v18, 3, v2
    v_and_b32 v4, 3, v0
    v_lshlrev_b32 v4, 3, v4
    v_and_b32_e64 v5, 16, v0
    v_lshl_add_u32 v4, v5, 1, v4
    v_lshl_add_u32 v28, v3, 6, v4
    v_add_u32 v28, 98304, v28
    v_lshl_add_u32 v3, v3, 7, v4
    v_and_b32 v4, 8, v0
    v_lshlrev_b32 v4, 3, v4
    v_xor_b32_e64 v26, v3, v4
    v_lshl_add_u32 v2, v18, 2, v2
    v_lshl_add_u32 v2, v2, 5, v5
    v_and_b32_e64 v4, 2, v0
    v_lshl_add_u32 v2, v4, 2, v2
    v_add_u32 v29, 131072, v2
    v_add_u32 v26, s39, v26
    v_xor_b32 v27, 64, v26
    v_lshl_add_u32 v29, s93, 10, v29
    v_lshrrev_b32_e64 v2, 2, v0
    v_mul_u32_u24 v2, 3072, v2
    v_and_b32_e64 v3, 3, v0
    v_lshl_add_u32 v30, v3, 4, v2
    s_mul_i32 s84, s76, 49152
    s_lshl_b32 s85, s78, 7
    s_add_u32 s84, s84, s85
    s_lshl_b32 s85, s93, 6
    s_add_u32 s84, s84, s85
    s_mov_b64 s[48:49], s[24:25]
    s_mov_b32 s50, 0x180000
    s_mov_b32 s51, 0x20000
    v_lshl_add_u32 v31, v14, 10, v1
    v_xor_b32 v2, 64, v31
    v_add_u32 v32, 7168, v2
    v_add_u32 v33, 14336, v31
    v_add_u32 v34, 21504, v2
    v_lshl_add_u32 v35, v14, 10, v15
    v_add_u32 v36, 7168, v35
    v_add_u32 v37, 14336, v35
    v_add_u32 v38, 21504, v35
    s_lshl_b32 s85, s78, 1
    s_add_u32 s85, s85, s93
    v_lshl_add_u32 v39, s85, 10, v16
    s_lshl_b32 s85, s93, 6
    s_add_u32 s85, s85, 135168
    v_xor_b32 v40, s85, v1
    v_bfe_u32 v2, v0, 3, 2
    v_bfe_u32 v3, v0, 1, 1
    v_lshl_add_u32 v2, v2, 1, v3
    v_bfe_u32 v3, v0, 2, 1
    v_xor_b32_e64 v4, v3, v18
    v_lshl_add_u32 v2, v4, 3, v2
    v_and_b32 v4, 1, v0
    v_lshlrev_b32 v4, 4, v4
    v_mov_b32 v5, 0x3f80
    v_lshlrev_b32_e64 v5, v4, v5
    v_cmp_eq_u32 s[94:95], 0, v2
    v_cmp_eq_u32 s[96:97], 1, v2
    s_nop 0
    v_cndmask_b32 v50, 0, v5, s[94:95]
    v_cndmask_b32 v51, 0, v5, s[96:97]
    v_cmp_eq_u32 s[94:95], 2, v2
    v_cmp_eq_u32 s[96:97], 3, v2
    s_nop 0
    v_cndmask_b32 v52, 0, v5, s[94:95]
    v_cndmask_b32 v53, 0, v5, s[96:97]
    v_bfe_i32 v1, v0, 2, 1
    v_and_b32 v1, 0x80008000, v1
    s_mov_b64 s[56:57], s[16:17]
    s_mov_b32 s58, 0x80000
    s_mov_b32 s59, 0x20000
    s_mov_b64 s[60:61], s[28:29]
    s_mov_b32 s62, 0x80000
    s_mov_b32 s63, 0x20000
    v_and_b32 v2, 0x13, v0
    v_and_b32 v3, 4, v0
    v_lshl_add_u32 v2, v3, 1, v2
    v_bfe_u32 v3, v0, 3, 1
    v_lshl_add_u32 v14, v3, 2, v2
    s_lshl_b32 s85, s86, 9
    v_lshl_add_u32 v3, v14, 4, s85
    v_lshl_add_u32 v3, v18, 8, v3
    s_lshl_b32 s85, s86, 6
    s_add_u32 s85, s85, 1024
    v_lshl_add_u32 v4, v18, 5, s85
    v_cndmask_b32 v14, v4, v3, s[34:35]
    v_lshrrev_b32_e64 v15, 2, v0
    v_mul_u32_u24 v15, 1152, v15
    v_and_b32_e64 v3, 3, v0
    v_lshl_add_u32 v15, v3, 5, v15
    buffer_load_dwordx4 v8, s[40:43], s22 offen offset:2048 lds
    buffer_load_dwordx4 v9, s[40:43], s22 offen offset:3072 lds
    s_add_u32 m0, s92, 65536
    s_add_u32 s23, s83, s23
    buffer_load_dwordx4 v10, s[44:47], s23 offen offset:0 lds
    buffer_load_dwordx4 v11, s[44:47], s23 offen offset:1024 lds
    buffer_load_dwordx4 v12, s[44:47], s23 offen offset:2048 lds
    buffer_load_dwordx4 v13, s[44:47], s23 offen offset:3072 lds
    s_waitcnt lgkmcnt(0)
    s_add_u32 s0, s0, 0x9e3779b1
    s_mov_b32 s1, s0
    v_mov_b32 v58, s0
    v_mov_b32_e64 v59, s0
    v_and_b32 v60, 0xff, v58
    s_and_b32 s30, s0, 1
    s_xor_b32 s31, s30, 1
    s_mov_b64 s[52:53], s[14:15]
    s_mov_b32 s54, 0x80000
    s_waitcnt vmcnt(8)
    s_barrier
    ds_read_b64_tr_b16 v[190:191], v29 offset:0
    ds_read_b64_tr_b16 v[192:193], v29 offset:256
    ds_read_b64_tr_b16 v[194:195], v29 offset:512
    ds_read_b64_tr_b16 v[196:197], v29 offset:768
    ds_read_b128 v[62:65], v22 offset:0
    ds_read_b128 v[66:69], v23 offset:0
    ds_read_b128 v[70:73], v24 offset:0
    ds_read_b128 v[74:77], v25 offset:0
    ds_read_b128 v[42:45], v39 offset:0
    ds_read_b128 v[46:49], v40 offset:0
    s_add_u32 s3, s79, 2
    s_and_b32 s3, s3, 7
    s_lshl_b32 s22, s3, 7
    s_add_u32 s22, s82, s22
    s_add_u32 m0, s92, 32768
    s_mul_i32 s23, s3, s89
    buffer_load_dwordx4 v6, s[40:43], s22 offen offset:0 lds
    buffer_load_dwordx4 v7, s[40:43], s22 offen offset:1024 lds
    buffer_load_dwordx4 v8, s[40:43], s22 offen offset:2048 lds
    buffer_load_dwordx4 v9, s[40:43], s22 offen offset:3072 lds
    s_add_u32 m0, s92, 81920
    s_add_u32 s23, s83, s23
    buffer_load_dwordx4 v10, s[44:47], s23 offen offset:0 lds
    buffer_load_dwordx4 v11, s[44:47], s23 offen offset:1024 lds
    buffer_load_dwordx4 v12, s[44:47], s23 offen offset:2048 lds
    buffer_load_dwordx4 v13, s[44:47], s23 offen offset:3072 lds
    s_waitcnt lgkmcnt(0)
    v_dot2_f32_bf16 v41, v42, v46, 0
    v_dot2_f32_bf16 v41, v43, v47, v41
    v_dot2_f32_bf16 v41, v44, v48, v41
    v_dot2_f32_bf16 v41, v45, v49, v41
    s_waitcnt vmcnt(8)
    s_barrier
    ds_read_b128 v[78:81], v22 offset:16384
    ds_read_b128 v[82:85], v23 offset:16384
    ds_read_b128 v[86:89], v24 offset:16384
    ds_read_b128 v[90:93], v25 offset:16384
    ds_read_b128 v[42:45], v39 offset:16384
    ds_read_b128 v[46:49], v40 offset:128
    s_add_u32 s3, s79, 3
    s_and_b32 s3, s3, 7
    s_lshl_b32 s22, s3, 7
    s_add_u32 s22, s82, s22
    s_add_u32 m0, s92, 0
    s_mul_i32 s23, s3, s89
    buffer_load_dwordx4 v6, s[40:43], s22 offen offset:0 lds
    buffer_load_dwordx4 v7, s[40:43], s22 offen offset:1024 lds
    buffer_load_dwordx4 v8, s[40:43], s22 offen offset:2048 lds
    buffer_load_dwordx4 v9, s[40:43], s22 offen offset:3072 lds
    s_add_u32 m0, s92, 49152
    s_add_u32 s23, s83, s23
    buffer_load_dwordx4 v10, s[44:47], s23 offen offset:0 lds
    buffer_load_dwordx4 v11, s[44:47], s23 offen offset:1024 lds
    buffer_load_dwordx4 v12, s[44:47], s23 offen offset:2048 lds
    buffer_load_dwordx4 v13, s[44:47], s23 offen offset:3072 lds
    v_xor_b32 v190, v1, v190
    v_xor_b32 v191, v1, v191
    v_xor_b32 v192, v1, v192
    v_xor_b32 v193, v1, v193
    v_xor_b32 v194, v1, v194
    v_xor_b32 v195, v1, v195
    v_xor_b32 v196, v1, v196
    v_xor_b32 v197, v1, v197
    s_waitcnt lgkmcnt(0)
    v_dot2_f32_bf16 v41, v42, v46, v41
    v_dot2_f32_bf16 v41, v43, v47, v41
    v_dot2_f32_bf16 v41, v44, v48, v41
    v_dot2_f32_bf16 v41, v45, v49, v41
    s_waitcnt vmcnt(8)
    s_barrier
    ds_read_b128 v[94:97], v22 offset:32768
    ds_read_b128 v[98:101], v23 offset:32768
    ds_read_b128 v[102:105], v24 offset:32768
    ds_read_b128 v[106:109], v25 offset:32768
    ds_read_b128 v[42:45], v39 offset:32768
    ds_read_b128 v[46:49], v40 offset:256
    s_add_u32 s3, s79, 4
    s_and_b32 s3, s3, 7
    s_lshl_b32 s22, s3, 7
    s_add_u32 s22, s82, s22
    s_add_u32 m0, s92, 16384
    s_mul_i32 s23, s3, s89
    buffer_load_dwordx4 v6, s[40:43], s22 offen offset:0 lds
    buffer_load_dwordx4 v7, s[40:43], s22 offen offset:1024 lds
    buffer_load_dwordx4 v8, s[40:43], s22 offen offset:2048 lds
    buffer_load_dwordx4 v9, s[40:43], s22 offen offset:3072 lds
    s_add_u32 m0, s92, 65536
    s_add_u32 s23, s83, s23
    buffer_load_dwordx4 v10, s[44:47], s23 offen offset:0 lds
    buffer_load_dwordx4 v11, s[44:47], s23 offen offset:1024 lds
    buffer_load_dwordx4 v12, s[44:47], s23 offen offset:2048 lds
    buffer_load_dwordx4 v13, s[44:47], s23 offen offset:3072 lds
    s_waitcnt lgkmcnt(0)
    v_dot2_f32_bf16 v41, v42, v46, v41
    v_dot2_f32_bf16 v41, v43, v47, v41
    v_dot2_f32_bf16 v41, v44, v48, v41
    v_dot2_f32_bf16 v41, v45, v49, v41
    s_waitcnt vmcnt(8)
    s_barrier
    ds_read_b128 v[110:113], v22 offset:0
    ds_read_b128 v[114:117], v23 offset:0
    ds_read_b128 v[118:121], v24 offset:0
    ds_read_b128 v[122:125], v25 offset:0
    ds_read_b128 v[42:45], v39 offset:0
    ds_read_b128 v[46:49], v40 offset:384
    s_add_u32 s3, s79, 5
    s_and_b32 s3, s3, 7
    s_lshl_b32 s22, s3, 7
    s_add_u32 s22, s82, s22
    s_add_u32 m0, s92, 32768
    s_mul_i32 s23, s3, s89
    buffer_load_dwordx4 v6, s[40:43], s22 offen offset:0 lds
    buffer_load_dwordx4 v7, s[40:43], s22 offen offset:1024 lds
    buffer_load_dwordx4 v8, s[40:43], s22 offen offset:2048 lds
    buffer_load_dwordx4 v9, s[40:43], s22 offen offset:3072 lds
    s_add_u32 m0, s92, 81920
    s_add_u32 s23, s83, s23
    buffer_load_dwordx4 v10, s[44:47], s23 offen offset:0 lds
    buffer_load_dwordx4 v11, s[44:47], s23 offen offset:1024 lds
    buffer_load_dwordx4 v12, s[44:47], s23 offen offset:2048 lds
    buffer_load_dwordx4 v13, s[44:47], s23 offen offset:3072 lds
    s_waitcnt lgkmcnt(0)
    v_dot2_f32_bf16 v41, v42, v46, v41
    v_dot2_f32_bf16 v41, v43, v47, v41
    v_dot2_f32_bf16 v41, v44, v48, v41
    v_dot2_f32_bf16 v41, v45, v49, v41
    s_waitcnt vmcnt(8)
    s_barrier
    ds_read_b128 v[126:129], v22 offset:16384
    ds_read_b128 v[130:133], v23 offset:16384
    ds_read_b128 v[134:137], v24 offset:16384
    ds_read_b128 v[138:141], v25 offset:16384
    ds_read_b128 v[42:45], v39 offset:16384
    ds_read_b128 v[46:49], v40 offset:512
    s_add_u32 s3, s79, 6
    s_and_b32 s3, s3, 7
    s_lshl_b32 s22, s3, 7
    s_add_u32 s22, s82, s22
    s_add_u32 m0, s92, 0
    s_mul_i32 s23, s3, s89
    buffer_load_dwordx4 v6, s[40:43], s22 offen offset:0 lds
    buffer_load_dwordx4 v7, s[40:43], s22 offen offset:1024 lds
    buffer_load_dwordx4 v8, s[40:43], s22 offen offset:2048 lds
    buffer_load_dwordx4 v9, s[40:43], s22 offen offset:3072 lds
    s_add_u32 m0, s92, 49152
    s_add_u32 s23, s83, s23
    buffer_load_dwordx4 v10, s[44:47], s23 offen offset:0 lds
    buffer_load_dwordx4 v11, s[44:47], s23 offen offset:1024 lds
    buffer_load_dwordx4 v12, s[44:47], s23 offen offset:2048 lds
    buffer_load_dwordx4 v13, s[44:47], s23 offen offset:3072 lds
    s_waitcnt lgkmcnt(0)
    v_dot2_f32_bf16 v41, v42, v46, v41
    v_dot2_f32_bf16 v41, v43, v47, v41
    v_dot2_f32_bf16 v41, v44, v48, v41
    v_dot2_f32_bf16 v41, v45, v49, v41
    s_waitcnt vmcnt(8)
    s_barrier
    ds_read_b128 v[142:145], v22 offset:32768
    ds_read_b128 v[146:149], v23 offset:32768
    ds_read_b128 v[150:153], v24 offset:32768
    ds_read_b128 v[154:157], v25 offset:32768
    ds_read_b128 v[42:45], v39 offset:32768
    ds_read_b128 v[46:49], v40 offset:640
    s_add_u32 s3, s79, 7
    s_and_b32 s3, s3, 7
    s_lshl_b32 s22, s3, 7
    s_add_u32 s22, s82, s22
    s_add_u32 m0, s92, 16384
    s_mul_i32 s23, s3, s89
    buffer_load_dwordx4 v6, s[40:43], s22 offen offset:0 lds
    buffer_load_dwordx4 v7, s[40:43], s22 offen offset:1024 lds
    buffer_load_dwordx4 v8, s[40:43], s22 offen offset:2048 lds
    buffer_load_dwordx4 v9, s[40:43], s22 offen offset:3072 lds
    s_add_u32 m0, s92, 65536
    s_add_u32 s23, s83, s23
    buffer_load_dwordx4 v10, s[44:47], s23 offen offset:0 lds
    buffer_load_dwordx4 v11, s[44:47], s23 offen offset:1024 lds
    buffer_load_dwordx4 v12, s[44:47], s23 offen offset:2048 lds
    buffer_load_dwordx4 v13, s[44:47], s23 offen offset:3072 lds
    s_waitcnt lgkmcnt(0)
    v_dot2_f32_bf16 v41, v42, v46, v41
    v_dot2_f32_bf16 v41, v43, v47, v41
    v_dot2_f32_bf16 v41, v44, v48, v41
    v_dot2_f32_bf16 v41, v45, v49, v41
    s_waitcnt vmcnt(8)
    s_barrier
    ds_read_b128 v[158:161], v22 offset:0
    ds_read_b128 v[162:165], v23 offset:0
    ds_read_b128 v[166:169], v24 offset:0
    ds_read_b128 v[170:173], v25 offset:0
    ds_read_b128 v[42:45], v39 offset:0
    ds_read_b128 v[46:49], v40 offset:768
    s_add_u32 s3, s79, 0
    s_and_b32 s3, s3, 7
    s_mul_i32 s3, s3, 196608
    s_add_u32 s23, s84, s3
    s_lshr_b32 s3, s92, 2
    s_add_u32 m0, s3, 98304
    s_nop 0
    buffer_load_dwordx4 v30, s[48:51], s23 offen lds
    s_add_u32 s3, s79, 1
    s_and_b32 s3, s3, 7
    s_mul_i32 s3, s3, 196608
    s_add_u32 s23, s84, s3
    s_lshr_b32 s3, s92, 2
    s_add_u32 m0, s3, 102400
    s_nop 0
    buffer_load_dwordx4 v30, s[48:51], s23 offen lds
    s_add_u32 s3, s79, 2
    s_and_b32 s3, s3, 7
    s_mul_i32 s3, s3, 196608
    s_add_u32 s23, s84, s3
    s_lshr_b32 s3, s92, 2
    s_add_u32 m0, s3, 106496
    s_nop 0
    buffer_load_dwordx4 v30, s[48:51], s23 offen lds
    s_add_u32 s3, s79, 3
    s_and_b32 s3, s3, 7
    s_mul_i32 s3, s3, 196608
    s_add_u32 s23, s84, s3
    s_lshr_b32 s3, s92, 2
    s_add_u32 m0, s3, 110592
    s_nop 0
    buffer_load_dwordx4 v30, s[48:51], s23 offen lds
    s_waitcnt lgkmcnt(0)
    v_dot2_f32_bf16 v41, v42, v46, v41
    v_dot2_f32_bf16 v41, v43, v47, v41
    v_dot2_f32_bf16 v41, v44, v48, v41
    v_dot2_f32_bf16 v41, v45, v49, v41
    s_waitcnt vmcnt(4)
    s_barrier
    ds_read_b128 v[174:177], v22 offset:16384
    ds_read_b128 v[178:181], v23 offset:16384
    ds_read_b128 v[182:185], v24 offset:16384
    ds_read_b128 v[186:189], v25 offset:16384
    ds_read_b128 v[42:45], v39 offset:16384
    ds_read_b128 v[46:49], v40 offset:896
    s_add_u32 s3, s79, 4
    s_and_b32 s3, s3, 7
    s_mul_i32 s3, s3, 196608
    s_add_u32 s23, s84, s3
    s_lshr_b32 s3, s92, 2
    s_add_u32 m0, s3, 114688
    s_nop 0
    buffer_load_dwordx4 v30, s[48:51], s23 offen lds
    s_add_u32 s3, s79, 5
    s_and_b32 s3, s3, 7
    s_mul_i32 s3, s3, 196608
    s_add_u32 s23, s84, s3
    s_lshr_b32 s3, s92, 2
    s_add_u32 m0, s3, 118784
    s_nop 0
    buffer_load_dwordx4 v30, s[48:51], s23 offen lds
    s_add_u32 s3, s79, 6
    s_and_b32 s3, s3, 7
    s_mul_i32 s3, s3, 196608
    s_add_u32 s23, s84, s3
    s_lshr_b32 s3, s92, 2
    s_add_u32 m0, s3, 122880
    s_nop 0
    buffer_load_dwordx4 v30, s[48:51], s23 offen lds
    s_add_u32 s3, s79, 7
    s_and_b32 s3, s3, 7
    s_mul_i32 s3, s3, 196608
    s_add_u32 s23, s84, s3
    s_lshr_b32 s3, s92, 2
    s_add_u32 m0, s3, 126976
    s_nop 0
    buffer_load_dwordx4 v30, s[48:51], s23 offen lds
    s_lshl_b32 s22, s76, 17
    s_lshl_b32 s3, s81, 7
    s_add_u32 s22, s22, s3
    s_add_u32 s22, s22, 0
    s_add_u32 m0, s39, 32768
    s_waitcnt vmcnt(7)
    buffer_load_dwordx4 v35, s[60:63], s22 offen offset:0 lds
    s_waitcnt vmcnt(7)
    buffer_load_dwordx4 v36, s[60:63], s22 offen offset:1024 lds
    s_waitcnt vmcnt(7)
    buffer_load_dwordx4 v37, s[60:63], s22 offen offset:2048 lds
    s_waitcnt vmcnt(7)
    buffer_load_dwordx4 v38, s[60:63], s22 offen offset:3072 lds
    s_lshl_b32 s22, s76, 17
    s_lshl_b32 s3, s81, 7
    s_add_u32 s22, s22, s3
    s_add_u32 s22, s22, 32768
    s_add_u32 m0, s39, 36864
    s_waitcnt vmcnt(7)
    buffer_load_dwordx4 v35, s[60:63], s22 offen offset:0 lds
    s_waitcnt vmcnt(7)
    buffer_load_dwordx4 v36, s[60:63], s22 offen offset:1024 lds
    s_waitcnt vmcnt(7)
    buffer_load_dwordx4 v37, s[60:63], s22 offen offset:2048 lds
    s_waitcnt vmcnt(7)
    buffer_load_dwordx4 v38, s[60:63], s22 offen offset:3072 lds
    s_setprio 2
    s_waitcnt lgkmcnt(0)
    v_dot2_f32_bf16 v41, v42, v46, v41
    v_dot2_f32_bf16 v41, v43, v47, v41
    v_dot2_f32_bf16 v41, v44, v48, v41
    v_dot2_f32_bf16 v41, v45, v49, v41
    v_and_b32 v3, 8, v0
    v_lshl_add_u32 v3, v18, 4, v3
    v_bfe_u32 v4, v0, 4, 1
    v_add_f32_dpp v41, v41, v41 row_half_mirror row_mask:0xf bank_mask:0xf
    v_add_u32 v3, v3, v4
    v_and_b32 v4, 7, v0
    v_add_f32_dpp v41, v41, v41 quad_perm:[1,0,3,2] row_mask:0xf bank_mask:0xf
    v_lshlrev_b32_e64 v4, 3, v4
    v_lshl_add_u32 v3, v3, 6, v4
    v_add_f32_dpp v41, v41, v41 quad_perm:[2,3,0,1] row_mask:0xf bank_mask:0xf
    s_lshr_b32 s85, s78, 1
    s_lshl_b32 s3, s77, 2
    v_mul_f32_e64 v41, s90, v41
    v_exp_f32 v41, -v41
    s_add_u32 s85, s85, s3
    s_lshl_b32 s85, s85, 3
    v_add_f32 v41, 1.0, v41
    v_rcp_f32 v41, v41
    s_and_b32 s3, s78, 1
    s_add_u32 s85, s85, s3
    s_lshl_b32 s85, s85, 1
    s_add_u32 s85, s85, s93
    s_lshl_b32 s85, s85, 7
    s_add_u32 s85, s85, 0x6a0000
    s_cmp_eq_u32 s76, 0
    s_cselect_b32 s85, s85, 0x700000
    v_and_b32 v4, 0xffffff00, v41
    v_or_b32 v4, v4, v60
    v_mov_b32 v5, v4
    buffer_store_dwordx2 v[4:5], v3, s[64:67], s85 offen sc1
    s_setprio 0
    s_mov_b64 exec, 1
    ds_write_b32 v20, v19 offset:16
    s_mov_b64 exec, -1
    s_lshl_b32 s22, s76, 17
    s_lshl_b32 s3, s81, 7
    s_add_u32 s22, s22, s3
    s_add_u32 s22, s22, 65536
    s_add_u32 m0, s39, 0
    s_waitcnt vmcnt(7)
    buffer_load_dwordx4 v35, s[60:63], s22 offen offset:0 lds
    s_waitcnt vmcnt(7)
    buffer_load_dwordx4 v36, s[60:63], s22 offen offset:1024 lds
    s_waitcnt vmcnt(7)
    buffer_load_dwordx4 v37, s[60:63], s22 offen offset:2048 lds
    s_waitcnt vmcnt(7)
    buffer_load_dwordx4 v38, s[60:63], s22 offen offset:3072 lds
    s_lshl_b32 s22, s76, 17
    s_lshl_b32 s3, s81, 7
    s_add_u32 s22, s22, s3
    s_add_u32 s22, s22, 98304
    s_add_u32 m0, s39, 4096
    s_waitcnt vmcnt(7)
    buffer_load_dwordx4 v35, s[60:63], s22 offen offset:0 lds
    s_waitcnt vmcnt(7)
    buffer_load_dwordx4 v36, s[60:63], s22 offen offset:1024 lds
    s_waitcnt vmcnt(7)
    buffer_load_dwordx4 v37, s[60:63], s22 offen offset:2048 lds
    s_waitcnt vmcnt(7)
    buffer_load_dwordx4 v38, s[60:63], s22 offen offset:3072 lds
    s_setprio 2
L_Q_wq:
    ds_read_b128 v[2:5], v19 offset:16
    s_waitcnt lgkmcnt(0)
    v_min3_u32 v2, v2, v3, v4
    v_min_u32 v2, v2, v5
    v_cmp_eq_u32 vcc, 0, v2
    s_cbranch_vccnz L_Q_wq_r
L_Q_wq_d:
L_Q_rf:
    ds_read_b128 v[2:5], v19 offset:0
    s_waitcnt lgkmcnt(0)
    v_min3_u32 v2, v2, v3, v4
    v_min_u32 v2, v2, v5
    v_cmp_eq_u32 vcc, 0, v2
    s_cbranch_vccnz L_Q_rf_r
L_Q_rf_d:
    s_setprio 0
    s_cmp_lg_u32 s93, 0
    s_cbranch_scc1 L_QS
    s_lshl_b32 s22, s81, 16
    s_lshl_b32 s3, s76, 8
    s_add_u32 s22, s22, s3
    s_add_u32 s22, s22, 0
    s_add_u32 m0, s39, 16384
    s_waitcnt vmcnt(7)
    buffer_load_dwordx4 v31, s[52:55], s22 offen offset:0 lds
    s_waitcnt vmcnt(7)
    buffer_load_dwordx4 v32, s[52:55], s22 offen offset:1024 lds
    s_waitcnt vmcnt(7)
    buffer_load_dwordx4 v33, s[52:55], s22 offen offset:2048 lds
    s_waitcnt vmcnt(7)
    buffer_load_dwordx4 v34, s[52:55], s22 offen offset:3072 lds
    s_lshl_b32 s22, s81, 16
    s_lshl_b32 s3, s76, 8
    s_add_u32 s22, s22, s3
    s_add_u32 s22, s22, 32768
    s_add_u32 m0, s39, 20480
    s_waitcnt vmcnt(7)
    buffer_load_dwordx4 v31, s[52:55], s22 offen offset:0 lds
    s_waitcnt vmcnt(7)
    buffer_load_dwordx4 v32, s[52:55], s22 offen offset:1024 lds
    s_waitcnt vmcnt(7)
    buffer_load_dwordx4 v33, s[52:55], s22 offen offset:2048 lds
    s_waitcnt vmcnt(7)
    buffer_load_dwordx4 v34, s[52:55], s22 offen offset:3072 lds
    ds_read_b64_tr_b16 v[198:199], v26 offset:32768
    ds_read_b64_tr_b16 v[200:201], v26 offset:33280
    ds_read_b64_tr_b16 v[202:203], v26 offset:34816
    ds_read_b64_tr_b16 v[204:205], v26 offset:35328
    ds_read_b64_tr_b16 v[206:207], v26 offset:36864
    ds_read_b64_tr_b16 v[208:209], v26 offset:37376
    ds_read_b64_tr_b16 v[210:211], v26 offset:38912
    ds_read_b64_tr_b16 v[212:213], v26 offset:39424
    ds_read_b64_tr_b16 v[214:215], v27 offset:32768
    ds_read_b64_tr_b16 v[216:217], v27 offset:33280
    ds_read_b64_tr_b16 v[218:219], v27 offset:34816
    ds_read_b64_tr_b16 v[220:221], v27 offset:35328
    ds_read_b64_tr_b16 v[222:223], v27 offset:36864
    ds_read_b64_tr_b16 v[224:225], v27 offset:37376
    ds_read_b64_tr_b16 v[226:227], v27 offset:38912
    ds_read_b64_tr_b16 v[228:229], v27 offset:39424
    s_waitcnt lgkmcnt(0)
    s_lshl_b32 s22, s81, 16
    s_lshl_b32 s3, s76, 8
    s_add_u32 s22, s22, s3
    s_add_u32 s22, s22, 0
    s_add_u32 m0, s39, 32768
    s_waitcnt vmcnt(7)
    buffer_load_dwordx4 v31, s[56:59], s22 offen offset:0 lds
    s_waitcnt vmcnt(7)
    buffer_load_dwordx4 v32, s[56:59], s22 offen offset:1024 lds
    s_waitcnt vmcnt(7)
    buffer_load_dwordx4 v33, s[56:59], s22 offen offset:2048 lds
    s_waitcnt vmcnt(7)
    buffer_load_dwordx4 v34, s[56:59], s22 offen offset:3072 lds
    s_lshl_b32 s22, s81, 16
    s_lshl_b32 s3, s76, 8
    s_add_u32 s22, s22, s3
    s_add_u32 s22, s22, 32768
    s_add_u32 m0, s39, 36864
    s_waitcnt vmcnt(7)
    buffer_load_dwordx4 v31, s[56:59], s22 offen offset:0 lds
    s_waitcnt vmcnt(7)
    buffer_load_dwordx4 v32, s[56:59], s22 offen offset:1024 lds
    s_waitcnt vmcnt(7)
    buffer_load_dwordx4 v33, s[56:59], s22 offen offset:2048 lds
    s_waitcnt vmcnt(7)
    buffer_load_dwordx4 v34, s[56:59], s22 offen offset:3072 lds
    s_setprio 2
L_Q_go:
    ds_read_b32 v2, v20 offset:80
    s_waitcnt lgkmcnt(0)
    v_cmp_eq_u32 vcc, 0, v2
    s_cbranch_vccnz L_Q_go_r
L_Q_go_d:
    s_setprio 0
    ds_read_b64_tr_b16 v[6:7], v28 offset:0
    ds_read_b64_tr_b16 v[8:9], v28 offset:256
    ds_read_b64_tr_b16 v[10:11], v28 offset:1024
    ds_read_b64_tr_b16 v[12:13], v28 offset:1280
    ds_read_b64_tr_b16 v[22:23], v28 offset:2048
    ds_read_b64_tr_b16 v[24:25], v28 offset:2304
    ds_read_b64_tr_b16 v[40:41], v28 offset:3072
    ds_read_b64_tr_b16 v[42:43], v28 offset:3328
    ds_read_b64_tr_b16 v[44:45], v28 offset:4096
    ds_read_b64_tr_b16 v[46:47], v28 offset:4352
    s_waitcnt lgkmcnt(8)
    v_mfma_f32_32x32x16_bf16 v[230:245], v[6:9], v[62:65], 0
    ds_read_b64_tr_b16 v[6:7], v28 offset:5120
    ds_read_b64_tr_b16 v[8:9], v28 offset:5376
    s_waitcnt lgkmcnt(8)
    v_mfma_f32_32x32x16_bf16 v[230:245], v[10:13], v[66:69], v[230:245]
    ds_read_b64_tr_b16 v[10:11], v28 offset:6144
    ds_read_b64_tr_b16 v[12:13], v28 offset:6400
    s_waitcnt lgkmcnt(8)
    v_mfma_f32_32x32x16_bf16 v[230:245], v[22:25], v[70:73], v[230:245]
    ds_read_b64_tr_b16 v[22:23], v28 offset:7168
    ds_read_b64_tr_b16 v[24:25], v28 offset:7424
    s_waitcnt lgkmcnt(8)
    v_mfma_f32_32x32x16_bf16 v[230:245], v[40:43], v[74:77], v[230:245]
    ds_read_b64_tr_b16 v[40:41], v28 offset:8192
    ds_read_b64_tr_b16 v[42:43], v28 offset:8448
    s_waitcnt lgkmcnt(8)
    v_mfma_f32_32x32x16_bf16 v[230:245], v[44:47], v[78:81], v[230:245]
    ds_read_b64_tr_b16 v[44:45], v28 offset:9216
    ds_read_b64_tr_b16 v[46:47], v28 offset:9472
    s_waitcnt lgkmcnt(8)
    v_mfma_f32_32x32x16_bf16 v[230:245], v[6:9], v[82:85], v[230:245]
    ds_read_b64_tr_b16 v[6:7], v28 offset:10240
    ds_read_b64_tr_b16 v[8:9], v28 offset:10496
    s_waitcnt lgkmcnt(8)
    v_mfma_f32_32x32x16_bf16 v[230:245], v[10:13], v[86:89], v[230:245]
    ds_read_b64_tr_b16 v[10:11], v28 offset:11264
    ds_read_b64_tr_b16 v[12:13], v28 offset:11520
    s_waitcnt lgkmcnt(8)
    v_mfma_f32_32x32x16_bf16 v[230:245], v[22:25], v[90:93], v[230:245]
    ds_read_b64_tr_b16 v[22:23], v28 offset:12288
    ds_read_b64_tr_b16 v[24:25], v28 offset:12544
    s_waitcnt lgkmcnt(8)
    v_mfma_f32_32x32x16_bf16 v[230:245], v[40:43], v[94:97], v[230:245]
    ds_read_b64_tr_b16 v[62:63], v26 offset:0
    ds_read_b64_tr_b16 v[64:65], v26 offset:512
    ds_read_b64_tr_b16 v[40:41], v28 offset:13312
    ds_read_b64_tr_b16 v[42:43], v28 offset:13568
    s_waitcnt lgkmcnt(10)
    v_mfma_f32_32x32x16_bf16 v[230:245], v[44:47], v[98:101], v[230:245]
    ds_read_b64_tr_b16 v[66:67], v26 offset:2048
    ds_read_b64_tr_b16 v[68:69], v26 offset:2560
    ds_read_b64_tr_b16 v[44:45], v28 offset:14336
    ds_read_b64_tr_b16 v[46:47], v28 offset:14592
    s_waitcnt lgkmcnt(12)
    v_mfma_f32_32x32x16_bf16 v[230:245], v[6:9], v[102:105], v[230:245]
    ds_read_b64_tr_b16 v[70:71], v26 offset:4096
    ds_read_b64_tr_b16 v[72:73], v26 offset:4608
    ds_read_b64_tr_b16 v[6:7], v28 offset:15360
    ds_read_b64_tr_b16 v[8:9], v28 offset:15616
    s_waitcnt lgkmcnt(14)
    v_mfma_f32_32x32x16_bf16 v[230:245], v[10:13], v[106:109], v[230:245]
    ds_read_b64_tr_b16 v[74:75], v26 offset:6144
    ds_read_b64_tr_b16 v[76:77], v26 offset:6656
    ds_read_b64_tr_b16 v[10:11], v28 offset:16384
    ds_read_b64_tr_b16 v[12:13], v28 offset:16640
    s_waitcnt lgkmcnt(15)
    v_mfma_f32_32x32x16_bf16 v[230:245], v[22:25], v[110:113], v[230:245]
    ds_read_b64_tr_b16 v[78:79], v27 offset:0
    ds_read_b64_tr_b16 v[80:81], v27 offset:512
    ds_read_b64_tr_b16 v[22:23], v28 offset:17408
    ds_read_b64_tr_b16 v[24:25], v28 offset:17664
    s_waitcnt lgkmcnt(15)
    v_mfma_f32_32x32x16_bf16 v[230:245], v[40:43], v[114:117], v[230:245]
    ds_read_b64_tr_b16 v[82:83], v27 offset:2048
    ds_read_b64_tr_b16 v[84:85], v27 offset:2560
    ds_read_b64_tr_b16 v[40:41], v28 offset:18432
    ds_read_b64_tr_b16 v[42:43], v28 offset:18688
    s_waitcnt lgkmcnt(15)
    v_mfma_f32_32x32x16_bf16 v[230:245], v[44:47], v[118:121], v[230:245]
    ds_read_b64_tr_b16 v[86:87], v27 offset:4096
    ds_read_b64_tr_b16 v[88:89], v27 offset:4608
    ds_read_b64_tr_b16 v[44:45], v28 offset:19456
    ds_read_b64_tr_b16 v[46:47], v28 offset:19712
    s_waitcnt lgkmcnt(15)
    v_mfma_f32_32x32x16_bf16 v[230:245], v[6:9], v[122:125], v[230:245]
    ds_read_b64_tr_b16 v[90:91], v27 offset:6144
    ds_read_b64_tr_b16 v[92:93], v27 offset:6656
    ds_read_b64_tr_b16 v[6:7], v28 offset:20480
    ds_read_b64_tr_b16 v[8:9], v28 offset:20736
    s_waitcnt lgkmcnt(15)
    v_mfma_f32_32x32x16_bf16 v[230:245], v[10:13], v[126:129], v[230:245]
    ds_read_b64_tr_b16 v[10:11], v28 offset:21504
    ds_read_b64_tr_b16 v[12:13], v28 offset:21760
    s_waitcnt lgkmcnt(14)
    v_mfma_f32_32x32x16_bf16 v[230:245], v[22:25], v[130:133], v[230:245]
    s_waitcnt lgkmcnt(4)
    s_lshl_b32 s22, s81, 16
    s_lshl_b32 s3, s76, 8
    s_add_u32 s22, s22, s3
    s_add_u32 s22, s22, 128
    s_add_u32 m0, s39, 0
    s_waitcnt vmcnt(7)
    buffer_load_dwordx4 v31, s[52:55], s22 offen offset:0 lds
    ds_read_b64_tr_b16 v[22:23], v28 offset:22528
    ds_read_b64_tr_b16 v[24:25], v28 offset:22784
    v_mfma_f32_32x32x16_bf16 v[230:245], v[40:43], v[134:137], v[230:245]
    ds_read_b64_tr_b16 v[40:41], v28 offset:23552
    ds_read_b64_tr_b16 v[42:43], v28 offset:23808
    v_mfma_f32_32x32x16_bf16 v[230:245], v[44:47], v[138:141], v[230:245]
    s_waitcnt vmcnt(7)
    buffer_load_dwordx4 v32, s[52:55], s22 offen offset:1024 lds
    ds_read_b64_tr_b16 v[44:45], v28 offset:24576
    ds_read_b64_tr_b16 v[46:47], v28 offset:24832
    s_waitcnt lgkmcnt(8)
    v_mfma_f32_32x32x16_bf16 v[230:245], v[6:9], v[142:145], v[230:245]
    ds_read_b64_tr_b16 v[6:7], v28 offset:25600
    ds_read_b64_tr_b16 v[8:9], v28 offset:25856
    s_waitcnt lgkmcnt(8)
    v_mfma_f32_32x32x16_bf16 v[230:245], v[10:13], v[146:149], v[230:245]
    s_waitcnt vmcnt(7)
    buffer_load_dwordx4 v33, s[52:55], s22 offen offset:2048 lds
    ds_read_b64_tr_b16 v[10:11], v28 offset:26624
    ds_read_b64_tr_b16 v[12:13], v28 offset:26880
    s_waitcnt lgkmcnt(8)
    v_mfma_f32_32x32x16_bf16 v[230:245], v[22:25], v[150:153], v[230:245]
    ds_read_b64_tr_b16 v[22:23], v28 offset:27648
    ds_read_b64_tr_b16 v[24:25], v28 offset:27904
    s_waitcnt lgkmcnt(8)
    v_mfma_f32_32x32x16_bf16 v[230:245], v[40:43], v[154:157], v[230:245]
    s_waitcnt vmcnt(7)
    buffer_load_dwordx4 v34, s[52:55], s22 offen offset:3072 lds
    ds_read_b64_tr_b16 v[40:41], v28 offset:28672
    ds_read_b64_tr_b16 v[42:43], v28 offset:28928
    s_waitcnt lgkmcnt(8)
    v_mfma_f32_32x32x16_bf16 v[230:245], v[44:47], v[158:161], v[230:245]
    ds_read_b64_tr_b16 v[44:45], v28 offset:29696
    ds_read_b64_tr_b16 v[46:47], v28 offset:29952
    s_waitcnt lgkmcnt(8)
    v_mfma_f32_32x32x16_bf16 v[230:245], v[6:9], v[162:165], v[230:245]
    s_lshl_b32 s22, s81, 16
    s_lshl_b32 s3, s76, 8
    s_add_u32 s22, s22, s3
    s_add_u32 s22, s22, 32896
    s_add_u32 m0, s39, 4096
    s_waitcnt vmcnt(7)
    buffer_load_dwordx4 v31, s[52:55], s22 offen offset:0 lds
    ds_read_b64_tr_b16 v[6:7], v28 offset:30720
    ds_read_b64_tr_b16 v[8:9], v28 offset:30976
    s_waitcnt lgkmcnt(8)
    v_mfma_f32_32x32x16_bf16 v[230:245], v[10:13], v[166:169], v[230:245]
    ds_read_b64_tr_b16 v[10:11], v28 offset:31744
    ds_read_b64_tr_b16 v[12:13], v28 offset:32000
    s_waitcnt lgkmcnt(8)
    v_mfma_f32_32x32x16_bf16 v[230:245], v[22:25], v[170:173], v[230:245]
    s_waitcnt vmcnt(7)
    buffer_load_dwordx4 v32, s[52:55], s22 offen offset:1024 lds
    s_waitcnt lgkmcnt(6)
    v_mfma_f32_32x32x16_bf16 v[230:245], v[40:43], v[174:177], v[230:245]
    s_waitcnt lgkmcnt(4)
    v_mfma_f32_32x32x16_bf16 v[230:245], v[44:47], v[178:181], v[230:245]
    s_waitcnt vmcnt(7)
    buffer_load_dwordx4 v33, s[52:55], s22 offen offset:2048 lds
    s_waitcnt lgkmcnt(2)
    v_mfma_f32_32x32x16_bf16 v[230:245], v[6:9], v[182:185], v[230:245]
    s_waitcnt lgkmcnt(0)
    v_mfma_f32_32x32x16_bf16 v[230:245], v[10:13], v[186:189], v[230:245]
    s_waitcnt vmcnt(7)
    buffer_load_dwordx4 v34, s[52:55], s22 offen offset:3072 lds
    s_mov_b64 exec, 1
    ds_write_b32 v20, v19 offset:32
    s_mov_b64 exec, -1
    s_branch L_QJ
.p2align 3
L_QS:
    ds_read_b64_tr_b16 v[198:199], v26 offset:32768
    ds_read_b64_tr_b16 v[200:201], v26 offset:33280
    ds_read_b64_tr_b16 v[202:203], v26 offset:34816
    ds_read_b64_tr_b16 v[204:205], v26 offset:35328
    ds_read_b64_tr_b16 v[206:207], v26 offset:36864
    ds_read_b64_tr_b16 v[208:209], v26 offset:37376
    ds_read_b64_tr_b16 v[210:211], v26 offset:38912
    ds_read_b64_tr_b16 v[212:213], v26 offset:39424
    ds_read_b64_tr_b16 v[214:215], v27 offset:32768
    ds_read_b64_tr_b16 v[216:217], v27 offset:33280
    ds_read_b64_tr_b16 v[218:219], v27 offset:34816
    ds_read_b64_tr_b16 v[220:221], v27 offset:35328
    ds_read_b64_tr_b16 v[222:223], v27 offset:36864
    ds_read_b64_tr_b16 v[224:225], v27 offset:37376
    ds_read_b64_tr_b16 v[226:227], v27 offset:38912
    ds_read_b64_tr_b16 v[228:229], v27 offset:39424
    s_setprio 2
L_QS_go:
    ds_read_b32 v2, v20 offset:80
    s_waitcnt lgkmcnt(0)
    v_cmp_eq_u32 vcc, 0, v2
    s_cbranch_vccnz L_QS_go_r
L_QS_go_d:
    s_setprio 0
    ds_read_b64_tr_b16 v[6:7], v28 offset:0
    ds_read_b64_tr_b16 v[8:9], v28 offset:256
    ds_read_b64_tr_b16 v[10:11], v28 offset:1024
    ds_read_b64_tr_b16 v[12:13], v28 offset:1280
    ds_read_b64_tr_b16 v[22:23], v28 offset:2048
    ds_read_b64_tr_b16 v[24:25], v28 offset:2304
    ds_read_b64_tr_b16 v[40:41], v28 offset:3072
    ds_read_b64_tr_b16 v[42:43], v28 offset:3328
    ds_read_b64_tr_b16 v[44:45], v28 offset:4096
    ds_read_b64_tr_b16 v[46:47], v28 offset:4352
    s_waitcnt lgkmcnt(8)
    v_mfma_f32_32x32x16_bf16 v[230:245], v[6:9], v[62:65], 0
    s_lshl_b32 s22, s81, 16
    s_lshl_b32 s3, s76, 8
    s_add_u32 s22, s22, s3
    s_add_u32 s22, s22, 0
    s_add_u32 m0, s39, 16384
    s_waitcnt vmcnt(7)
    buffer_load_dwordx4 v31, s[52:55], s22 offen offset:0 lds
    ds_read_b64_tr_b16 v[6:7], v28 offset:5120
    ds_read_b64_tr_b16 v[8:9], v28 offset:5376
    s_waitcnt lgkmcnt(8)
    v_mfma_f32_32x32x16_bf16 v[230:245], v[10:13], v[66:69], v[230:245]
    ds_read_b64_tr_b16 v[10:11], v28 offset:6144
    ds_read_b64_tr_b16 v[12:13], v28 offset:6400
    s_waitcnt lgkmcnt(8)
    v_mfma_f32_32x32x16_bf16 v[230:245], v[22:25], v[70:73], v[230:245]
    ds_read_b64_tr_b16 v[22:23], v28 offset:7168
    ds_read_b64_tr_b16 v[24:25], v28 offset:7424
    s_waitcnt lgkmcnt(8)
    v_mfma_f32_32x32x16_bf16 v[230:245], v[40:43], v[74:77], v[230:245]
    s_waitcnt vmcnt(7)
    buffer_load_dwordx4 v32, s[52:55], s22 offen offset:1024 lds
    ds_read_b64_tr_b16 v[40:41], v28 offset:8192
    ds_read_b64_tr_b16 v[42:43], v28 offset:8448
    s_waitcnt lgkmcnt(8)
    v_mfma_f32_32x32x16_bf16 v[230:245], v[44:47], v[78:81], v[230:245]
    ds_read_b64_tr_b16 v[44:45], v28 offset:9216
    ds_read_b64_tr_b16 v[46:47], v28 offset:9472
    s_waitcnt lgkmcnt(8)
    v_mfma_f32_32x32x16_bf16 v[230:245], v[6:9], v[82:85], v[230:245]
    ds_read_b64_tr_b16 v[6:7], v28 offset:10240
    ds_read_b64_tr_b16 v[8:9], v28 offset:10496
    s_waitcnt lgkmcnt(8)
    v_mfma_f32_32x32x16_bf16 v[230:245], v[10:13], v[86:89], v[230:245]
    s_waitcnt vmcnt(7)
    buffer_load_dwordx4 v33, s[52:55], s22 offen offset:2048 lds
    ds_read_b64_tr_b16 v[10:11], v28 offset:11264
    ds_read_b64_tr_b16 v[12:13], v28 offset:11520
    s_waitcnt lgkmcnt(8)
    v_mfma_f32_32x32x16_bf16 v[230:245], v[22:25], v[90:93], v[230:245]
    ds_read_b64_tr_b16 v[22:23], v28 offset:12288
    ds_read_b64_tr_b16 v[24:25], v28 offset:12544
    s_waitcnt lgkmcnt(8)
    v_mfma_f32_32x32x16_bf16 v[230:245], v[40:43], v[94:97], v[230:245]
    ds_read_b64_tr_b16 v[40:41], v28 offset:13312
    ds_read_b64_tr_b16 v[42:43], v28 offset:13568
    s_waitcnt lgkmcnt(8)
    v_mfma_f32_32x32x16_bf16 v[230:245], v[44:47], v[98:101], v[230:245]
    s_waitcnt vmcnt(7)
    buffer_load_dwordx4 v34, s[52:55], s22 offen offset:3072 lds
    ds_read_b64_tr_b16 v[44:45], v28 offset:14336
    ds_read_b64_tr_b16 v[46:47], v28 offset:14592
    s_waitcnt lgkmcnt(8)
    v_mfma_f32_32x32x16_bf16 v[230:245], v[6:9], v[102:105], v[230:245]
    ds_read_b64_tr_b16 v[6:7], v28 offset:15360
    ds_read_b64_tr_b16 v[8:9], v28 offset:15616
    s_waitcnt lgkmcnt(8)
    v_mfma_f32_32x32x16_bf16 v[230:245], v[10:13], v[106:109], v[230:245]
    ds_read_b64_tr_b16 v[10:11], v28 offset:16384
    ds_read_b64_tr_b16 v[12:13], v28 offset:16640
    s_waitcnt lgkmcnt(8)
    v_mfma_f32_32x32x16_bf16 v[230:245], v[22:25], v[110:113], v[230:245]
    s_lshl_b32 s22, s81, 16
    s_lshl_b32 s3, s76, 8
    s_add_u32 s22, s22, s3
    s_add_u32 s22, s22, 32768
    s_add_u32 m0, s39, 20480
    s_waitcnt vmcnt(7)
    buffer_load_dwordx4 v31, s[52:55], s22 offen offset:0 lds
    ds_read_b64_tr_b16 v[22:23], v28 offset:17408
    ds_read_b64_tr_b16 v[24:25], v28 offset:17664
    s_waitcnt lgkmcnt(8)
    v_mfma_f32_32x32x16_bf16 v[230:245], v[40:43], v[114:117], v[230:245]
    ds_read_b64_tr_b16 v[40:41], v28 offset:18432
    ds_read_b64_tr_b16 v[42:43], v28 offset:18688
    s_waitcnt lgkmcnt(8)
    v_mfma_f32_32x32x16_bf16 v[230:245], v[44:47], v[118:121], v[230:245]
    ds_read_b64_tr_b16 v[44:45], v28 offset:19456
    ds_read_b64_tr_b16 v[46:47], v28 offset:19712
    s_waitcnt lgkmcnt(8)
    v_mfma_f32_32x32x16_bf16 v[230:245], v[6:9], v[122:125], v[230:245]
    ds_read_b64_tr_b16 v[6:7], v28 offset:20480
    ds_read_b64_tr_b16 v[8:9], v28 offset:20736
    s_waitcnt lgkmcnt(8)
    v_mfma_f32_32x32x16_bf16 v[230:245], v[10:13], v[126:129], v[230:245]
    s_waitcnt vmcnt(7)
    buffer_load_dwordx4 v32, s[52:55], s22 offen offset:1024 lds
    s_waitcnt vmcnt(6)
    ds_read_b64_tr_b16 v[62:63], v26 offset:0
    ds_read_b64_tr_b16 v[64:65], v26 offset:512
    ds_read_b64_tr_b16 v[10:11], v28 offset:21504
    ds_read_b64_tr_b16 v[12:13], v28 offset:21760
    s_waitcnt lgkmcnt(10)
    v_mfma_f32_32x32x16_bf16 v[230:245], v[22:25], v[130:133], v[230:245]
    ds_read_b64_tr_b16 v[66:67], v26 offset:2048
    ds_read_b64_tr_b16 v[68:69], v26 offset:2560
    ds_read_b64_tr_b16 v[22:23], v28 offset:22528
    ds_read_b64_tr_b16 v[24:25], v28 offset:22784
    s_waitcnt lgkmcnt(12)
    v_mfma_f32_32x32x16_bf16 v[230:245], v[40:43], v[134:137], v[230:245]
    ds_read_b64_tr_b16 v[70:71], v26 offset:4096
    ds_read_b64_tr_b16 v[72:73], v26 offset:4608
    ds_read_b64_tr_b16 v[40:41], v28 offset:23552
    ds_read_b64_tr_b16 v[42:43], v28 offset:23808
    s_waitcnt lgkmcnt(14)
    v_mfma_f32_32x32x16_bf16 v[230:245], v[44:47], v[138:141], v[230:245]
    buffer_load_dwordx4 v33, s[52:55], s22 offen offset:2048 lds
    ds_read_b64_tr_b16 v[74:75], v26 offset:6144
    ds_read_b64_tr_b16 v[76:77], v26 offset:6656
    ds_read_b64_tr_b16 v[44:45], v28 offset:24576
    ds_read_b64_tr_b16 v[46:47], v28 offset:24832
    s_waitcnt lgkmcnt(15)
    v_mfma_f32_32x32x16_bf16 v[230:245], v[6:9], v[142:145], v[230:245]
    ds_read_b64_tr_b16 v[78:79], v27 offset:0
    ds_read_b64_tr_b16 v[80:81], v27 offset:512
    ds_read_b64_tr_b16 v[6:7], v28 offset:25600
    ds_read_b64_tr_b16 v[8:9], v28 offset:25856
    s_waitcnt lgkmcnt(15)
    v_mfma_f32_32x32x16_bf16 v[230:245], v[10:13], v[146:149], v[230:245]
    ds_read_b64_tr_b16 v[82:83], v27 offset:2048
    ds_read_b64_tr_b16 v[84:85], v27 offset:2560
    ds_read_b64_tr_b16 v[10:11], v28 offset:26624
    ds_read_b64_tr_b16 v[12:13], v28 offset:26880
    s_waitcnt lgkmcnt(15)
    v_mfma_f32_32x32x16_bf16 v[230:245], v[22:25], v[150:153], v[230:245]
    buffer_load_dwordx4 v34, s[52:55], s22 offen offset:3072 lds
    ds_read_b64_tr_b16 v[86:87], v27 offset:4096
    ds_read_b64_tr_b16 v[88:89], v27 offset:4608
    ds_read_b64_tr_b16 v[22:23], v28 offset:27648
    ds_read_b64_tr_b16 v[24:25], v28 offset:27904
    s_waitcnt lgkmcnt(15)
    v_mfma_f32_32x32x16_bf16 v[230:245], v[40:43], v[154:157], v[230:245]
    ds_read_b64_tr_b16 v[90:91], v27 offset:6144
    ds_read_b64_tr_b16 v[92:93], v27 offset:6656
    ds_read_b64_tr_b16 v[40:41], v28 offset:28672
    ds_read_b64_tr_b16 v[42:43], v28 offset:28928
    s_waitcnt lgkmcnt(15)
    v_mfma_f32_32x32x16_bf16 v[230:245], v[44:47], v[158:161], v[230:245]
    ds_read_b64_tr_b16 v[44:45], v28 offset:29696
    ds_read_b64_tr_b16 v[46:47], v28 offset:29952
    s_waitcnt lgkmcnt(14)
    v_mfma_f32_32x32x16_bf16 v[230:245], v[6:9], v[162:165], v[230:245]
    s_lshl_b32 s22, s81, 16
    s_lshl_b32 s3, s76, 8
    s_add_u32 s22, s22, s3
    s_add_u32 s22, s22, 0
    s_add_u32 m0, s39, 32768
    s_waitcnt vmcnt(7)
    buffer_load_dwordx4 v31, s[56:59], s22 offen offset:0 lds
    ds_read_b64_tr_b16 v[6:7], v28 offset:30720
    ds_read_b64_tr_b16 v[8:9], v28 offset:30976
    s_waitcnt lgkmcnt(12)
    v_mfma_f32_32x32x16_bf16 v[230:245], v[10:13], v[166:169], v[230:245]
    ds_read_b64_tr_b16 v[10:11], v28 offset:31744
    ds_read_b64_tr_b16 v[12:13], v28 offset:32000
    s_waitcnt lgkmcnt(10)
    v_mfma_f32_32x32x16_bf16 v[230:245], v[22:25], v[170:173], v[230:245]
    s_waitcnt lgkmcnt(6)
    v_mfma_f32_32x32x16_bf16 v[230:245], v[40:43], v[174:177], v[230:245]
    s_waitcnt vmcnt(7)
    buffer_load_dwordx4 v32, s[56:59], s22 offen offset:1024 lds
    s_waitcnt lgkmcnt(4)
    v_mfma_f32_32x32x16_bf16 v[230:245], v[44:47], v[178:181], v[230:245]
    s_waitcnt lgkmcnt(2)
    v_mfma_f32_32x32x16_bf16 v[230:245], v[6:9], v[182:185], v[230:245]
    s_waitcnt lgkmcnt(0)
    v_mfma_f32_32x32x16_bf16 v[230:245], v[10:13], v[186:189], v[230:245]
    s_mov_b64 exec, 1
    ds_write_b32 v20, v19 offset:32
    s_mov_b64 exec, -1
    s_waitcnt vmcnt(7)
    buffer_load_dwordx4 v33, s[56:59], s22 offen offset:2048 lds
    s_waitcnt vmcnt(7)
    buffer_load_dwordx4 v34, s[56:59], s22 offen offset:3072 lds
    s_lshl_b32 s22, s81, 16
    s_lshl_b32 s3, s76, 8
    s_add_u32 s22, s22, s3
    s_add_u32 s22, s22, 32768
    s_add_u32 m0, s39, 36864
    s_waitcnt vmcnt(7)
    buffer_load_dwordx4 v31, s[56:59], s22 offen offset:0 lds
    s_waitcnt vmcnt(7)
    buffer_load_dwordx4 v32, s[56:59], s22 offen offset:1024 lds
    s_waitcnt vmcnt(7)
    buffer_load_dwordx4 v33, s[56:59], s22 offen offset:2048 lds
    s_waitcnt vmcnt(7)
    buffer_load_dwordx4 v34, s[56:59], s22 offen offset:3072 lds
    s_lshl_b32 s22, s81, 16
    s_lshl_b32 s3, s76, 8
    s_add_u32 s22, s22, s3
    s_add_u32 s22, s22, 128
    s_add_u32 m0, s39, 0
    s_waitcnt vmcnt(7)
    buffer_load_dwordx4 v31, s[52:55], s22 offen offset:0 lds
    s_waitcnt vmcnt(7)
    buffer_load_dwordx4 v32, s[52:55], s22 offen offset:1024 lds
    s_waitcnt vmcnt(7)
    buffer_load_dwordx4 v33, s[52:55], s22 offen offset:2048 lds
    s_waitcnt vmcnt(7)
    buffer_load_dwordx4 v34, s[52:55], s22 offen offset:3072 lds
    s_lshl_b32 s22, s81, 16
    s_lshl_b32 s3, s76, 8
    s_add_u32 s22, s22, s3
    s_add_u32 s22, s22, 32896
    s_add_u32 m0, s39, 4096
    s_waitcnt vmcnt(7)
    buffer_load_dwordx4 v31, s[52:55], s22 offen offset:0 lds
    s_waitcnt vmcnt(7)
    buffer_load_dwordx4 v32, s[52:55], s22 offen offset:1024 lds
    s_waitcnt vmcnt(7)
    buffer_load_dwordx4 v33, s[52:55], s22 offen offset:2048 lds
    s_waitcnt vmcnt(7)
    buffer_load_dwordx4 v34, s[52:55], s22 offen offset:3072 lds
L_QJ:
    s_nop 7
    s_setprio 2
L_Q_qd:
    ds_read_b128 v[2:5], v19 offset:32
    s_waitcnt lgkmcnt(0)
    v_min3_u32 v2, v2, v3, v4
    v_min_u32 v2, v2, v5
    v_cmp_eq_u32 vcc, 0, v2
    s_cbranch_vccnz L_Q_qd_r
    s_nop 0
L_Q_qd_d:
    v_cvt_pk_bf16_f32 v22, v230, v231
    v_cvt_pk_bf16_f32 v23, v232, v233
    v_cvt_pk_bf16_f32 v24, v234, v235
    v_cvt_pk_bf16_f32 v25, v236, v237
    v_cvt_pk_bf16_f32 v26, v238, v239
    v_cvt_pk_bf16_f32 v27, v240, v241
    v_cvt_pk_bf16_f32 v28, v242, v243
    v_cvt_pk_bf16_f32 v29, v244, v245
    v_mfma_f32_32x32x16_bf16 v[230:245], v[190:193], v[22:25], 0
    s_nop 0
    v_mfma_f32_32x32x16_bf16 v[94:109], v[194:197], v[26:29], 0
    s_setprio 0
    s_lshl_b32 s22, s81, 16
    s_lshl_b32 s3, s76, 8
    s_add_u32 s22, s22, s3
    s_add_u32 s22, s22, 128
    s_lshl_b32 s3, s76, 13
    s_add_u32 m0, s3, 98304
    s_waitcnt vmcnt(7)
    buffer_load_dwordx4 v31, s[56:59], s22 offen offset:0 lds
    s_waitcnt vmcnt(7)
    buffer_load_dwordx4 v32, s[56:59], s22 offen offset:1024 lds
    s_waitcnt vmcnt(7)
    buffer_load_dwordx4 v33, s[56:59], s22 offen offset:2048 lds
    s_waitcnt vmcnt(7)
    buffer_load_dwordx4 v34, s[56:59], s22 offen offset:3072 lds
    s_lshl_b32 s22, s81, 16
    s_lshl_b32 s3, s76, 8
    s_add_u32 s22, s22, s3
    s_add_u32 s22, s22, 32896
    s_lshl_b32 s3, s76, 13
    s_add_u32 m0, s3, 102400
    s_waitcnt vmcnt(7)
    buffer_load_dwordx4 v31, s[56:59], s22 offen offset:0 lds
    s_waitcnt vmcnt(7)
    buffer_load_dwordx4 v32, s[56:59], s22 offen offset:1024 lds
    s_waitcnt vmcnt(7)
    buffer_load_dwordx4 v33, s[56:59], s22 offen offset:2048 lds
    s_waitcnt vmcnt(7)
    buffer_load_dwordx4 v34, s[56:59], s22 offen offset:3072 lds
    s_lshl_b32 s85, s78, 1
    s_add_u32 s85, s85, s93
    s_lshl_b32 s85, s85, 1
    s_add_u32 s85, s85, s87
    s_mul_i32 s85, s85, 18432
    s_add_u32 s84, s85, 0x600000
    buffer_load_dwordx4 v[54:57], v15, s[64:67], s84 offen offset:1024 sc1
    v_max3_f32 v40, v230, v231, v232
    v_max3_f32 v40, v40, v233, v234
    v_max3_f32 v40, v40, v235, v236
    v_max3_f32 v40, v40, v237, v238
    v_max3_f32 v40, v40, v239, v240
    v_max3_f32 v40, v40, v241, v242
    v_max3_f32 v40, v40, v243, v244
    v_max_f32 v40, v40, v245
    v_mul_f32 v40, s90, v40
    v_pk_fma_f32 v[230:231], v[230:231], s[90:91], v[40:41] op_sel_hi:[1,1,0] neg_lo:[0,0,1] neg_hi:[0,0,1]
    v_pk_fma_f32 v[232:233], v[232:233], s[90:91], v[40:41] op_sel_hi:[1,1,0] neg_lo:[0,0,1] neg_hi:[0,0,1]
    v_pk_fma_f32 v[234:235], v[234:235], s[90:91], v[40:41] op_sel_hi:[1,1,0] neg_lo:[0,0,1] neg_hi:[0,0,1]
    v_pk_fma_f32 v[236:237], v[236:237], s[90:91], v[40:41] op_sel_hi:[1,1,0] neg_lo:[0,0,1] neg_hi:[0,0,1]
    v_pk_fma_f32 v[238:239], v[238:239], s[90:91], v[40:41] op_sel_hi:[1,1,0] neg_lo:[0,0,1] neg_hi:[0,0,1]
    v_pk_fma_f32 v[240:241], v[240:241], s[90:91], v[40:41] op_sel_hi:[1,1,0] neg_lo:[0,0,1] neg_hi:[0,0,1]
    v_pk_fma_f32 v[242:243], v[242:243], s[90:91], v[40:41] op_sel_hi:[1,1,0] neg_lo:[0,0,1] neg_hi:[0,0,1]
    v_pk_fma_f32 v[244:245], v[244:245], s[90:91], v[40:41] op_sel_hi:[1,1,0] neg_lo:[0,0,1] neg_hi:[0,0,1]
    v_exp_f32 v230, v230
    v_exp_f32 v231, v231
    v_exp_f32 v232, v232
    v_exp_f32 v233, v233
    v_exp_f32 v234, v234
    v_exp_f32 v235, v235
    v_exp_f32 v236, v236
    v_exp_f32 v237, v237
    v_exp_f32 v238, v238
    v_exp_f32 v239, v239
    v_exp_f32 v240, v240
    v_exp_f32 v241, v241
    v_exp_f32 v242, v242
    v_exp_f32 v243, v243
    v_exp_f32 v244, v244
    v_exp_f32 v245, v245
    v_pk_add_f32 v[40:41], v[230:231], v[232:233]
    v_pk_add_f32 v[40:41], v[40:41], v[234:235]
    v_pk_add_f32 v[40:41], v[40:41], v[236:237]
    v_pk_add_f32 v[40:41], v[40:41], v[238:239]
    v_pk_add_f32 v[40:41], v[40:41], v[240:241]
    v_pk_add_f32 v[40:41], v[40:41], v[242:243]
    v_pk_add_f32 v[40:41], v[40:41], v[244:245]
    v_add_f32 v40, v40, v41
    v_rcp_f32 v40, v40
    s_nop 0
    s_nop 0
    v_pk_mul_f32 v[230:231], v[40:41], v[230:231] op_sel:[0,0] op_sel_hi:[0,1]
    v_pk_mul_f32 v[232:233], v[40:41], v[232:233] op_sel:[0,0] op_sel_hi:[0,1]
    v_pk_mul_f32 v[234:235], v[40:41], v[234:235] op_sel:[0,0] op_sel_hi:[0,1]
    v_pk_mul_f32 v[236:237], v[40:41], v[236:237] op_sel:[0,0] op_sel_hi:[0,1]
    v_pk_mul_f32 v[238:239], v[40:41], v[238:239] op_sel:[0,0] op_sel_hi:[0,1]
    v_pk_mul_f32 v[240:241], v[40:41], v[240:241] op_sel:[0,0] op_sel_hi:[0,1]
    v_pk_mul_f32 v[242:243], v[40:41], v[242:243] op_sel:[0,0] op_sel_hi:[0,1]
    v_pk_mul_f32 v[244:245], v[40:41], v[244:245] op_sel:[0,0] op_sel_hi:[0,1]
    v_cvt_pk_bf16_f32 v6, v230, v231
    v_cvt_pk_bf16_f32 v7, v232, v233
    v_cvt_pk_bf16_f32 v8, v234, v235
    v_cvt_pk_bf16_f32 v9, v236, v237
    v_cvt_pk_bf16_f32 v10, v238, v239
    v_cvt_pk_bf16_f32 v11, v240, v241
    v_cvt_pk_bf16_f32 v12, v242, v243
    v_cvt_pk_bf16_f32 v13, v244, v245
    v_max3_f32 v40, v94, v95, v96
    v_max3_f32 v40, v40, v97, v98
    v_max3_f32 v40, v40, v99, v100
    v_max3_f32 v40, v40, v101, v102
    v_max3_f32 v40, v40, v103, v104
    v_max3_f32 v40, v40, v105, v106
    v_max3_f32 v40, v40, v107, v108
    v_max_f32 v40, v40, v109
    v_mul_f32 v40, s90, v40
    v_pk_fma_f32 v[94:95], v[94:95], s[90:91], v[40:41] op_sel_hi:[1,1,0] neg_lo:[0,0,1] neg_hi:[0,0,1]
    v_pk_fma_f32 v[96:97], v[96:97], s[90:91], v[40:41] op_sel_hi:[1,1,0] neg_lo:[0,0,1] neg_hi:[0,0,1]
    v_pk_fma_f32 v[98:99], v[98:99], s[90:91], v[40:41] op_sel_hi:[1,1,0] neg_lo:[0,0,1] neg_hi:[0,0,1]
    v_pk_fma_f32 v[100:101], v[100:101], s[90:91], v[40:41] op_sel_hi:[1,1,0] neg_lo:[0,0,1] neg_hi:[0,0,1]
    v_pk_fma_f32 v[102:103], v[102:103], s[90:91], v[40:41] op_sel_hi:[1,1,0] neg_lo:[0,0,1] neg_hi:[0,0,1]
    v_pk_fma_f32 v[104:105], v[104:105], s[90:91], v[40:41] op_sel_hi:[1,1,0] neg_lo:[0,0,1] neg_hi:[0,0,1]
    v_pk_fma_f32 v[106:107], v[106:107], s[90:91], v[40:41] op_sel_hi:[1,1,0] neg_lo:[0,0,1] neg_hi:[0,0,1]
    v_pk_fma_f32 v[108:109], v[108:109], s[90:91], v[40:41] op_sel_hi:[1,1,0] neg_lo:[0,0,1] neg_hi:[0,0,1]
    v_exp_f32 v94, v94
    v_exp_f32 v95, v95
    v_exp_f32 v96, v96
    v_exp_f32 v97, v97
    v_exp_f32 v98, v98
    v_exp_f32 v99, v99
    v_exp_f32 v100, v100
    v_exp_f32 v101, v101
    v_exp_f32 v102, v102
    v_exp_f32 v103, v103
    v_exp_f32 v104, v104
    v_exp_f32 v105, v105
    v_exp_f32 v106, v106
    v_exp_f32 v107, v107
    v_exp_f32 v108, v108
    v_exp_f32 v109, v109
    v_pk_add_f32 v[40:41], v[94:95], v[96:97]
    v_pk_add_f32 v[40:41], v[40:41], v[98:99]
    v_pk_add_f32 v[40:41], v[40:41], v[100:101]
    v_pk_add_f32 v[40:41], v[40:41], v[102:103]
    v_pk_add_f32 v[40:41], v[40:41], v[104:105]
    v_pk_add_f32 v[40:41], v[40:41], v[106:107]
    v_pk_add_f32 v[40:41], v[40:41], v[108:109]
    v_add_f32 v40, v40, v41
    v_rcp_f32 v40, v40
    s_nop 0
    s_nop 0
    v_pk_mul_f32 v[94:95], v[40:41], v[94:95] op_sel:[0,0] op_sel_hi:[0,1]
    v_pk_mul_f32 v[96:97], v[40:41], v[96:97] op_sel:[0,0] op_sel_hi:[0,1]
    v_pk_mul_f32 v[98:99], v[40:41], v[98:99] op_sel:[0,0] op_sel_hi:[0,1]
    v_pk_mul_f32 v[100:101], v[40:41], v[100:101] op_sel:[0,0] op_sel_hi:[0,1]
    v_pk_mul_f32 v[102:103], v[40:41], v[102:103] op_sel:[0,0] op_sel_hi:[0,1]
    v_pk_mul_f32 v[104:105], v[40:41], v[104:105] op_sel:[0,0] op_sel_hi:[0,1]
    v_pk_mul_f32 v[106:107], v[40:41], v[106:107] op_sel:[0,0] op_sel_hi:[0,1]
    v_pk_mul_f32 v[108:109], v[40:41], v[108:109] op_sel:[0,0] op_sel_hi:[0,1]
    v_cvt_pk_bf16_f32 v22, v94, v95
    v_cvt_pk_bf16_f32 v23, v96, v97
    v_cvt_pk_bf16_f32 v24, v98, v99
    v_cvt_pk_bf16_f32 v25, v100, v101
    v_cvt_pk_bf16_f32 v26, v102, v103
    v_cvt_pk_bf16_f32 v27, v104, v105
    v_cvt_pk_bf16_f32 v28, v106, v107
    v_cvt_pk_bf16_f32 v29, v108, v109
    s_setprio 2
    s_waitcnt vmcnt(1)
    s_mov_b64 exec, 1
    ds_write_b32 v20, v19 offset:96
    s_mov_b64 exec, -1
    s_waitcnt vmcnt(0)
L_Q_kp:
    v_bitop3_b32 v2, v54, v55, s30 bitop3:0xdb
    v_bitop3_b32 v3, v56, v57, s30 bitop3:0xdb
    v_or_b32 v2, v2, v3
    v_and_b32 v2, 1, v2
    v_cmp_ne_u32 vcc, 0, v2
    s_cbranch_vccnz L_Q_kp_r
L_Q_kp_d:
    s_add_u32 s23, s84, 0
    buffer_load_dwordx4 v[94:97], v14, s[64:67], s23 offen offset:0 sc1
    buffer_load_dwordx4 v[98:101], v14, s[64:67], s23 offen offset:1152 sc1
    buffer_load_dwordx4 v[102:105], v14, s[64:67], s23 offen offset:2304 sc1
    buffer_load_dwordx4 v[106:109], v14, s[64:67], s23 offen offset:3456 sc1
    s_add_u32 s23, s84, 4608
    buffer_load_dwordx4 v[110:113], v14, s[64:67], s23 offen offset:0 sc1
    buffer_load_dwordx4 v[114:117], v14, s[64:67], s23 offen offset:1152 sc1
    buffer_load_dwordx4 v[118:121], v14, s[64:67], s23 offen offset:2304 sc1
    buffer_load_dwordx4 v[122:125], v14, s[64:67], s23 offen offset:3456 sc1
    s_add_u32 s23, s84, 9216
    buffer_load_dwordx4 v[126:129], v14, s[64:67], s23 offen offset:0 sc1
    buffer_load_dwordx4 v[130:133], v14, s[64:67], s23 offen offset:1152 sc1
    buffer_load_dwordx4 v[134:137], v14, s[64:67], s23 offen offset:2304 sc1
    buffer_load_dwordx4 v[138:141], v14, s[64:67], s23 offen offset:3456 sc1
    s_add_u32 s23, s84, 13824
    buffer_load_dwordx4 v[142:145], v14, s[64:67], s23 offen offset:0 sc1
    buffer_load_dwordx4 v[146:149], v14, s[64:67], s23 offen offset:1152 sc1
    buffer_load_dwordx4 v[150:153], v14, s[64:67], s23 offen offset:2304 sc1
    buffer_load_dwordx4 v[154:157], v14, s[64:67], s23 offen offset:3456 sc1
    v_add_u32 v46, 139264, v16
    s_lshr_b32 s85, s92, 2
    v_add_u32 v47, s85, v46
    s_mul_i32 s85, s86, 98304
    s_add_u32 s85, s85, s38
    s_lshl_b32 s3, s93, 11
    s_add_u32 s85, s85, s3
    s_add_u32 s83, s85, 8192
L_Q_ksum:
    s_waitcnt vmcnt(15)
    v_mfma_f32_32x32x16_bf16 v[30:45], v[50:53], v[94:97], 0
    v_bitop3_b32 v2, v94, v95, s30 bitop3:0xdb
    v_bitop3_b32 v3, v96, v97, s30 bitop3:0xdb
    v_or_b32 v1, v2, v3
    s_waitcnt vmcnt(14)
    v_mfma_f32_32x32x16_bf16 v[30:45], v[50:53], v[98:101], v[30:45]
    v_bitop3_b32 v2, v98, v99, s30 bitop3:0xdb
    v_bitop3_b32 v3, v100, v101, s30 bitop3:0xdb
    v_or3_b32 v1, v1, v2, v3
    s_waitcnt vmcnt(13)
    v_mfma_f32_32x32x16_bf16 v[30:45], v[50:53], v[102:105], v[30:45]
    v_bitop3_b32 v2, v102, v103, s30 bitop3:0xdb
    v_bitop3_b32 v3, v104, v105, s30 bitop3:0xdb
    v_or3_b32 v1, v1, v2, v3
    s_waitcnt vmcnt(12)
    v_mfma_f32_32x32x16_bf16 v[30:45], v[50:53], v[106:109], v[30:45]
    v_bitop3_b32 v2, v106, v107, s30 bitop3:0xdb
    v_bitop3_b32 v3, v108, v109, s30 bitop3:0xdb
    v_or3_b32 v1, v1, v2, v3
    s_waitcnt vmcnt(11)
    v_mfma_f32_32x32x16_bf16 v[30:45], v[50:53], v[110:113], v[30:45]
    v_bitop3_b32 v2, v110, v111, s30 bitop3:0xdb
    v_bitop3_b32 v3, v112, v113, s30 bitop3:0xdb
    v_or3_b32 v1, v1, v2, v3
    s_waitcnt vmcnt(10)
    v_mfma_f32_32x32x16_bf16 v[30:45], v[50:53], v[114:117], v[30:45]
    v_bitop3_b32 v2, v114, v115, s30 bitop3:0xdb
    v_bitop3_b32 v3, v116, v117, s30 bitop3:0xdb
    v_or3_b32 v1, v1, v2, v3
    s_waitcnt vmcnt(9)
    v_mfma_f32_32x32x16_bf16 v[30:45], v[50:53], v[118:121], v[30:45]
    v_bitop3_b32 v2, v118, v119, s30 bitop3:0xdb
    v_bitop3_b32 v3, v120, v121, s30 bitop3:0xdb
    v_or3_b32 v1, v1, v2, v3
    s_waitcnt vmcnt(8)
    v_mfma_f32_32x32x16_bf16 v[30:45], v[50:53], v[122:125], v[30:45]
    v_bitop3_b32 v2, v122, v123, s30 bitop3:0xdb
    v_bitop3_b32 v3, v124, v125, s30 bitop3:0xdb
    v_or3_b32 v1, v1, v2, v3
    s_waitcnt vmcnt(7)
    v_mfma_f32_32x32x16_bf16 v[30:45], v[50:53], v[126:129], v[30:45]
    v_bitop3_b32 v2, v126, v127, s30 bitop3:0xdb
    v_bitop3_b32 v3, v128, v129, s30 bitop3:0xdb
    v_or3_b32 v1, v1, v2, v3
    s_waitcnt vmcnt(6)
    v_mfma_f32_32x32x16_bf16 v[30:45], v[50:53], v[130:133], v[30:45]
    v_bitop3_b32 v2, v130, v131, s30 bitop3:0xdb
    v_bitop3_b32 v3, v132, v133, s30 bitop3:0xdb
    v_or3_b32 v1, v1, v2, v3
    s_waitcnt vmcnt(5)
    v_mfma_f32_32x32x16_bf16 v[30:45], v[50:53], v[134:137], v[30:45]
    v_bitop3_b32 v2, v134, v135, s30 bitop3:0xdb
    v_bitop3_b32 v3, v136, v137, s30 bitop3:0xdb
    v_or3_b32 v1, v1, v2, v3
    s_waitcnt vmcnt(4)
    v_mfma_f32_32x32x16_bf16 v[30:45], v[50:53], v[138:141], v[30:45]
    v_bitop3_b32 v2, v138, v139, s30 bitop3:0xdb
    v_bitop3_b32 v3, v140, v141, s30 bitop3:0xdb
    v_or3_b32 v1, v1, v2, v3
    s_waitcnt vmcnt(3)
    v_mfma_f32_32x32x16_bf16 v[30:45], v[50:53], v[142:145], v[30:45]
    v_bitop3_b32 v2, v142, v143, s30 bitop3:0xdb
    v_bitop3_b32 v3, v144, v145, s30 bitop3:0xdb
    v_or3_b32 v1, v1, v2, v3
    s_waitcnt vmcnt(2)
    v_mfma_f32_32x32x16_bf16 v[30:45], v[50:53], v[146:149], v[30:45]
    v_bitop3_b32 v2, v146, v147, s30 bitop3:0xdb
    v_bitop3_b32 v3, v148, v149, s30 bitop3:0xdb
    v_or3_b32 v1, v1, v2, v3
    s_waitcnt vmcnt(1)
    v_mfma_f32_32x32x16_bf16 v[30:45], v[50:53], v[150:153], v[30:45]
    v_bitop3_b32 v2, v150, v151, s30 bitop3:0xdb
    v_bitop3_b32 v3, v152, v153, s30 bitop3:0xdb
    v_or3_b32 v1, v1, v2, v3
    s_waitcnt vmcnt(0)
    v_mfma_f32_32x32x16_bf16 v[30:45], v[50:53], v[154:157], v[30:45]
    v_bitop3_b32 v2, v154, v155, s30 bitop3:0xdb
    v_bitop3_b32 v3, v156, v157, s30 bitop3:0xdb
    v_or3_b32 v1, v1, v2, v3
    v_and_b32 v1, 1, v1
    v_cmp_ne_u32 vcc, 0, v1
    s_cbranch_vccnz L_Q_kg_r
L_Q_kg_d:
    s_mul_i32 s38, s80, 196608
    s_mul_i32 s85, s76, 24576
    s_add_u32 s38, s38, s85
    v_bfe_u32 v3, v0, 3, 1
    v_mul_u32_u24 v3, 98304, v3
    v_and_b32_e64 v4, 16, v0
    v_lshl_add_u32 v3, v4, 7, v3
    v_mul_u32_u24 v4, 12288, v18
    v_and_b32 v15, 0x70, v16
    v_add3_u32 v15, v15, v3, v4
    v_add_u32 v15, 10112, v15
    v_add_u32 v14, 98304, v16
    v_cvt_pk_bf16_f32 v94, v30, v31
    v_cvt_pk_bf16_f32 v95, v32, v33
    v_cvt_pk_bf16_f32 v96, v34, v35
    v_cvt_pk_bf16_f32 v97, v36, v37
    ds_write_b128 v47, v[94:97]
    s_mov_b64 exec, 1
    ds_write_b32 v20, v19 offset:48
    s_mov_b64 exec, -1
L_Q_ks:
    ds_read_b128 v[2:5], v19 offset:48
    ds_read_b128 v[30:33], v46 offset:0
    ds_read_b128 v[34:37], v46 offset:1024
    ds_read_b128 v[38:41], v46 offset:2048
    ds_read_b128 v[42:45], v46 offset:3072
    s_waitcnt lgkmcnt(4)
    v_min3_u32 v2, v2, v3, v4
    v_min_u32 v2, v2, v5
    v_cmp_eq_u32 vcc, 0, v2
    s_cbranch_vccnz L_Q_ks_r
L_Q_ks_d:
    s_waitcnt lgkmcnt(0)
    v_mfma_f32_32x32x16_bf16 v[110:125], v[30:33], v[6:9], 0
    v_mfma_f32_32x32x16_bf16 v[110:125], v[34:37], v[10:13], v[110:125]
    v_mfma_f32_32x32x16_bf16 v[126:141], v[38:41], v[22:25], 0
    v_mfma_f32_32x32x16_bf16 v[126:141], v[42:45], v[26:29], v[126:141]
    s_nop 9
    v_add_f32 v118, 0x358637bd, v118
    v_rcp_f32 v118, v118
    s_nop 0
    v_mul_f32 v110, v118, v110
    v_mul_f32 v111, v118, v111
    v_mul_f32 v112, v118, v112
    v_mul_f32 v113, v118, v113
    v_mul_f32 v114, v118, v114
    v_mul_f32 v115, v118, v115
    v_mul_f32 v116, v118, v116
    v_mul_f32 v117, v118, v117
    v_cvt_pk_bf16_f32 v6, v110, v111
    v_cvt_pk_bf16_f32 v7, v112, v113
    v_cvt_pk_bf16_f32 v8, v114, v115
    v_cvt_pk_bf16_f32 v9, v116, v117
    v_and_or_b32 v6, v6, -2, s30
    v_and_or_b32 v7, v7, -2, s31
    v_and_or_b32 v8, v8, -2, s30
    v_and_or_b32 v9, v9, -2, s31
    buffer_store_dwordx4 v[6:9], v16, s[64:67], s83 offen offset:0 sc1
    v_add_f32 v134, 0x358637bd, v134
    v_rcp_f32 v134, v134
    s_nop 0
    v_mul_f32 v126, v134, v126
    v_mul_f32 v127, v134, v127
    v_mul_f32 v128, v134, v128
    v_mul_f32 v129, v134, v129
    v_mul_f32 v130, v134, v130
    v_mul_f32 v131, v134, v131
    v_mul_f32 v132, v134, v132
    v_mul_f32 v133, v134, v133
    v_cvt_pk_bf16_f32 v10, v126, v127
    v_cvt_pk_bf16_f32 v11, v128, v129
    v_cvt_pk_bf16_f32 v12, v130, v131
    v_cvt_pk_bf16_f32 v13, v132, v133
    v_and_or_b32 v10, v10, -2, s30
    v_and_or_b32 v11, v11, -2, s31
    v_and_or_b32 v12, v12, -2, s30
    v_and_or_b32 v13, v13, -2, s31
    buffer_store_dwordx4 v[10:13], v16, s[64:67], s83 offen offset:1024 sc1
    v_and_b32 v2, 16, v0
    v_lshrrev_b32 v2, 1, v2
    v_add_u32 v2, v2, v18
    s_lshl_b32 s85, s80, 5
    s_add_u32 s85, s85, s76
    s_lshl_b32 s85, s85, 1
    s_add_u32 s85, s85, 0
    v_add_u32 v2, s85, v2
    v_lshlrev_b32 v31, 6, v2
    v_and_b32 v3, 15, v0
    s_lshl_b32 s85, s81, 7
    v_lshl_add_u32 v3, v3, 3, s85
    v_lshl_add_u32 v2, v2, 10, v3
    v_add_u32 v4, 16384, v2
    v_lshlrev_b32 v30, 1, v2
    global_load_dwordx2 v[22:23], v2, s[4:5]
    global_load_dwordx2 v[24:25], v4, s[4:5]
    global_load_dwordx2 v[26:27], v3, s[20:21]
    s_mov_b32 s79, 0x6a0000
    buffer_load_dword v28, v31, s[64:67], s79 offen offset:0 sc1
    buffer_load_dword v29, v31, s[64:67], s79 offen offset:1024 sc1
    s_waitcnt vmcnt(0)
L_Q_g:
    v_bitop3_b32 v2, v28, v29, v60 bitop3:0x7e
    v_and_b32 v2, 0xff, v2
    v_cmp_ne_u32 vcc, 0, v2
    s_cbranch_vccnz L_Q_g_r
L_Q_g_d:
    v_lshlrev_b32 v2, 16, v26
    v_and_b32 v3, 0xffff0000, v26
    v_lshlrev_b32_e64 v4, 16, v27
    v_and_b32 v5, 0xffff0000, v27
    v_lshlrev_b32_e64 v32, 16, v22
    v_and_b32 v33, 0xffff0000, v22
    v_mul_f32 v32, v32, v2
    v_mul_f32 v33, v33, v3
    v_lshlrev_b32_e64 v34, 16, v23
    v_and_b32 v35, 0xffff0000, v23
    v_mul_f32 v34, v34, v4
    v_mul_f32 v35, v35, v5
    v_lshlrev_b32_e64 v36, 16, v24
    v_and_b32 v37, 0xffff0000, v24
    v_mul_f32 v36, v36, v2
    v_mul_f32 v37, v37, v3
    v_lshlrev_b32_e64 v38, 16, v25
    v_and_b32 v39, 0xffff0000, v25
    v_mul_f32 v38, v38, v4
    v_mul_f32 v39, v39, v5
    v_and_b32 v4, 7, v0
    v_xor_b32 v4, v4, v18
    v_lshlrev_b32_e64 v4, 4, v4
    v_lshl_add_u32 v4, v17, 8, v4
    s_lshl_b32 s85, s76, 14
    s_add_u32 s85, s85, 98304
    v_add_u32 v22, s85, v4
    v_xor_b32 v23, 32, v22
    v_xor_b32 v24, 64, v22
    v_xor_b32 v25, 96, v22
    v_lshrrev_b32 v4, 4, v0
    v_xor_b32 v4, v4, v0
    s_lshl_b32 s85, s76, 11
    v_lshl_add_u32 v4, v4, 4, s85
    v_add_u32 v40, 0, v4
    v_xor_b32_e64 v41, 64, v40
    v_add_u32 v42, 98304, v4
    v_xor_b32 v43, 64, v42
    s_mov_b64 s[68:69], s[32:33]
    s_mov_b32 s70, 0x400000
    s_mov_b32 s71, 0x20000
    buffer_load_dwordx4 v[54:57], v15, s[64:67], s38 offen sc1
    s_waitcnt vmcnt(0)
L_Q_op:
    v_bitop3_b32 v2, v54, v55, s30 bitop3:0xdb
    v_bitop3_b32 v3, v56, v57, s30 bitop3:0xdb
    v_or_b32 v2, v2, v3
    v_and_b32 v2, 1, v2
    v_cmp_ne_u32 vcc, 0, v2
    s_cbranch_vccnz L_Q_op_r
L_Q_op_d:
    s_add_u32 s23, s38, 8192
    buffer_load_dwordx4 v[6:9], v16, s[64:67], s23 offen offset:0 sc1
    buffer_load_dwordx4 v[10:13], v16, s[64:67], s23 offen offset:1024 sc1
    buffer_load_dwordx4 v[44:47], v16, s[64:67], s23 offen offset:2048 sc1
    buffer_load_dwordx4 v[48:51], v16, s[64:67], s23 offen offset:3072 sc1
    s_add_u32 s23, s38, 20480
    buffer_load_dwordx4 v[158:161], v16, s[64:67], s23 offen offset:0 sc1
    buffer_load_dwordx4 v[162:165], v16, s[64:67], s23 offen offset:1024 sc1
    buffer_load_dwordx4 v[166:169], v16, s[64:67], s23 offen offset:2048 sc1
    buffer_load_dwordx4 v[170:173], v16, s[64:67], s23 offen offset:3072 sc1
    s_add_u32 s23, s38, 8192
    buffer_load_dwordx4 v[174:177], v14, s[64:67], s23 offen offset:0 sc1
    buffer_load_dwordx4 v[178:181], v14, s[64:67], s23 offen offset:1024 sc1
    buffer_load_dwordx4 v[182:185], v14, s[64:67], s23 offen offset:2048 sc1
    buffer_load_dwordx4 v[186:189], v14, s[64:67], s23 offen offset:3072 sc1
    s_add_u32 s23, s38, 20480
    buffer_load_dwordx4 v[190:193], v14, s[64:67], s23 offen offset:0 sc1
    buffer_load_dwordx4 v[194:197], v14, s[64:67], s23 offen offset:1024 sc1
    buffer_load_dwordx4 v[230:233], v14, s[64:67], s23 offen offset:2048 sc1
    buffer_load_dwordx4 v[234:237], v14, s[64:67], s23 offen offset:3072 sc1
L_Q_oa:
    s_waitcnt vmcnt(15)
    v_mfma_f32_32x32x16_bf16 v[94:109], v[198:201], v[6:9], 0
    v_bitop3_b32 v2, v6, v7, s30 bitop3:0xdb
    v_bitop3_b32 v3, v8, v9, s30 bitop3:0xdb
    v_or_b32_e64 v1, v2, v3
    v_mfma_f32_32x32x16_bf16 v[126:141], v[214:217], v[6:9], 0
    s_waitcnt vmcnt(14)
    v_mfma_f32_32x32x16_bf16 v[94:109], v[202:205], v[10:13], v[94:109]
    v_bitop3_b32 v2, v10, v11, s30 bitop3:0xdb
    v_bitop3_b32 v3, v12, v13, s30 bitop3:0xdb
    v_or3_b32 v1, v1, v2, v3
    v_mfma_f32_32x32x16_bf16 v[126:141], v[218:221], v[10:13], v[126:141]
    s_waitcnt vmcnt(13)
    v_mfma_f32_32x32x16_bf16 v[94:109], v[206:209], v[44:47], v[94:109]
    v_bitop3_b32 v2, v44, v45, s30 bitop3:0xdb
    v_bitop3_b32 v3, v46, v47, s30 bitop3:0xdb
    v_or3_b32 v1, v1, v2, v3
    v_mfma_f32_32x32x16_bf16 v[126:141], v[222:225], v[44:47], v[126:141]
    s_waitcnt vmcnt(12)
    v_mfma_f32_32x32x16_bf16 v[94:109], v[210:213], v[48:51], v[94:109]
    v_bitop3_b32 v2, v48, v49, s30 bitop3:0xdb
    v_bitop3_b32 v3, v50, v51, s30 bitop3:0xdb
    v_or3_b32 v1, v1, v2, v3
    v_mfma_f32_32x32x16_bf16 v[126:141], v[226:229], v[48:51], v[126:141]
    s_waitcnt vmcnt(11)
    v_mfma_f32_32x32x16_bf16 v[94:109], v[62:65], v[158:161], v[94:109]
    v_bitop3_b32 v2, v158, v159, s30 bitop3:0xdb
    v_bitop3_b32 v3, v160, v161, s30 bitop3:0xdb
    v_or3_b32 v1, v1, v2, v3
    v_mfma_f32_32x32x16_bf16 v[126:141], v[78:81], v[158:161], v[126:141]
    s_waitcnt vmcnt(10)
    v_mfma_f32_32x32x16_bf16 v[94:109], v[66:69], v[162:165], v[94:109]
    v_bitop3_b32 v2, v162, v163, s30 bitop3:0xdb
    v_bitop3_b32 v3, v164, v165, s30 bitop3:0xdb
    v_or3_b32 v1, v1, v2, v3
    v_mfma_f32_32x32x16_bf16 v[126:141], v[82:85], v[162:165], v[126:141]
    s_waitcnt vmcnt(9)
    v_mfma_f32_32x32x16_bf16 v[94:109], v[70:73], v[166:169], v[94:109]
    v_bitop3_b32 v2, v166, v167, s30 bitop3:0xdb
    v_bitop3_b32 v3, v168, v169, s30 bitop3:0xdb
    v_or3_b32 v1, v1, v2, v3
    v_mfma_f32_32x32x16_bf16 v[126:141], v[86:89], v[166:169], v[126:141]
    s_waitcnt vmcnt(8)
    v_mfma_f32_32x32x16_bf16 v[94:109], v[74:77], v[170:173], v[94:109]
    v_bitop3_b32 v2, v170, v171, s30 bitop3:0xdb
    v_bitop3_b32 v3, v172, v173, s30 bitop3:0xdb
    v_or3_b32 v1, v1, v2, v3
    v_mfma_f32_32x32x16_bf16 v[126:141], v[90:93], v[170:173], v[126:141]
    v_and_b32 v1, 1, v1
    v_cmp_ne_u32 vcc, 0, v1
    s_cbranch_vccnz L_Q_oa_r
L_Q_oa_d:
    s_barrier
L_Q_ob:
    s_waitcnt vmcnt(7)
    v_mfma_f32_32x32x16_bf16 v[110:125], v[198:201], v[174:177], 0
    v_bitop3_b32 v2, v174, v175, s30 bitop3:0xdb
    v_bitop3_b32 v3, v176, v177, s30 bitop3:0xdb
    v_or_b32_e64 v1, v2, v3
    v_mfma_f32_32x32x16_bf16 v[142:157], v[214:217], v[174:177], 0
    s_waitcnt vmcnt(6)
    v_mfma_f32_32x32x16_bf16 v[110:125], v[202:205], v[178:181], v[110:125]
    v_bitop3_b32 v2, v178, v179, s30 bitop3:0xdb
    ds_write_b128 v22, v[94:97] offset:0
    v_bitop3_b32 v3, v180, v181, s30 bitop3:0xdb
    v_or3_b32 v1, v1, v2, v3
    v_mfma_f32_32x32x16_bf16 v[142:157], v[218:221], v[178:181], v[142:157]
    s_waitcnt vmcnt(5)
    v_mfma_f32_32x32x16_bf16 v[110:125], v[206:209], v[182:185], v[110:125]
    ds_write_b128 v23, v[98:101] offset:0
    v_bitop3_b32 v2, v182, v183, s30 bitop3:0xdb
    v_bitop3_b32 v3, v184, v185, s30 bitop3:0xdb
    v_or3_b32 v1, v1, v2, v3
    v_mfma_f32_32x32x16_bf16 v[142:157], v[222:225], v[182:185], v[142:157]
    s_waitcnt vmcnt(4)
    ds_write_b128 v24, v[102:105] offset:0
    v_mfma_f32_32x32x16_bf16 v[110:125], v[210:213], v[186:189], v[110:125]
    v_bitop3_b32 v2, v186, v187, s30 bitop3:0xdb
    v_bitop3_b32 v3, v188, v189, s30 bitop3:0xdb
    v_or3_b32 v1, v1, v2, v3
    v_mfma_f32_32x32x16_bf16 v[142:157], v[226:229], v[186:189], v[142:157]
    s_waitcnt vmcnt(3)
    ds_write_b128 v25, v[106:109] offset:0
    v_mfma_f32_32x32x16_bf16 v[110:125], v[62:65], v[190:193], v[110:125]
    v_bitop3_b32 v2, v190, v191, s30 bitop3:0xdb
    v_bitop3_b32 v3, v192, v193, s30 bitop3:0xdb
    v_or3_b32 v1, v1, v2, v3
    v_mfma_f32_32x32x16_bf16 v[142:157], v[78:81], v[190:193], v[142:157]
    ds_write_b128 v22, v[126:129] offset:128
    s_waitcnt vmcnt(2)
    v_mfma_f32_32x32x16_bf16 v[110:125], v[66:69], v[194:197], v[110:125]
    v_bitop3_b32 v2, v194, v195, s30 bitop3:0xdb
    v_bitop3_b32 v3, v196, v197, s30 bitop3:0xdb
    v_or3_b32 v1, v1, v2, v3
    ds_write_b128 v23, v[130:133] offset:128
    v_mfma_f32_32x32x16_bf16 v[142:157], v[82:85], v[194:197], v[142:157]
    s_waitcnt vmcnt(1)
    v_mfma_f32_32x32x16_bf16 v[110:125], v[70:73], v[230:233], v[110:125]
    v_bitop3_b32 v2, v230, v231, s30 bitop3:0xdb
    v_bitop3_b32 v3, v232, v233, s30 bitop3:0xdb
    ds_write_b128 v24, v[134:137] offset:128
    v_or3_b32 v1, v1, v2, v3
    v_mfma_f32_32x32x16_bf16 v[142:157], v[86:89], v[230:233], v[142:157]
    s_waitcnt vmcnt(0)
    v_mfma_f32_32x32x16_bf16 v[110:125], v[74:77], v[234:237], v[110:125]
    v_bitop3_b32 v2, v234, v235, s30 bitop3:0xdb
    ds_write_b128 v25, v[138:141] offset:128
    v_bitop3_b32 v3, v236, v237, s30 bitop3:0xdb
    v_or3_b32 v1, v1, v2, v3
    v_mfma_f32_32x32x16_bf16 v[142:157], v[90:93], v[234:237], v[142:157]
    v_and_b32 v1, 1, v1
    v_cmp_ne_u32 vcc, 0, v1
    s_cbranch_vccnz L_Q_ob_r
L_Q_ob_d:
    s_nop 3
    ds_write_b128 v22, v[110:113] offset:8192
    ds_write_b128 v23, v[114:117] offset:8192
    ds_write_b128 v24, v[118:121] offset:8192
    ds_write_b128 v25, v[122:125] offset:8192
    s_nop 0
    ds_write_b128 v22, v[142:145] offset:8320
    ds_write_b128 v23, v[146:149] offset:8320
    ds_write_b128 v24, v[150:153] offset:8320
    ds_write_b128 v25, v[154:157] offset:8320
    s_waitcnt lgkmcnt(0)
    s_barrier
    ds_read_b128 v[6:9], v40 offset:0
    ds_read_b128 v[10:13], v40 offset:8192
    ds_read_b128 v[44:47], v40 offset:49152
    ds_read_b128 v[48:51], v40 offset:57344
    ds_read_b128 v[158:161], v42 offset:0
    ds_read_b128 v[162:165], v42 offset:16384
    ds_read_b128 v[166:169], v42 offset:32768
    ds_read_b128 v[170:173], v42 offset:49152
    ds_read_b128 v[174:177], v41 offset:1024
    ds_read_b128 v[178:181], v41 offset:9216
    ds_read_b128 v[182:185], v41 offset:50176
    ds_read_b128 v[186:189], v41 offset:58368
    ds_read_b128 v[190:193], v43 offset:1024
    ds_read_b128 v[194:197], v43 offset:17408
    ds_read_b128 v[230:233], v43 offset:33792
    ds_read_b128 v[234:237], v43 offset:50176
    s_mov_b32 s23, 32768
    s_waitcnt lgkmcnt(12)
    s_nop 0
    v_pk_add_f32 v[32:33], v[32:33], v[6:7]
    v_pk_add_f32 v[34:35], v[34:35], v[8:9]
    v_pk_add_f32 v[32:33], v[32:33], v[10:11]
    v_pk_add_f32 v[34:35], v[34:35], v[12:13]
    v_pk_add_f32 v[32:33], v[32:33], v[44:45]
    v_pk_add_f32 v[34:35], v[34:35], v[46:47]
    v_pk_add_f32 v[32:33], v[32:33], v[48:49]
    v_pk_add_f32 v[34:35], v[34:35], v[50:51]
    s_waitcnt lgkmcnt(8)
    s_nop 0
    v_pk_add_f32 v[158:159], v[158:159], v[162:163]
    v_pk_add_f32 v[160:161], v[160:161], v[164:165]
    v_pk_add_f32 v[158:159], v[158:159], v[166:167]
    v_pk_add_f32 v[160:161], v[160:161], v[168:169]
    v_pk_add_f32 v[158:159], v[158:159], v[170:171]
    v_pk_add_f32 v[160:161], v[160:161], v[172:173]
    v_pk_add_f32 v[32:33], v[32:33], v[158:159] neg_lo:[0,1] neg_hi:[0,1]
    v_pk_add_f32 v[34:35], v[34:35], v[160:161] neg_lo:[0,1] neg_hi:[0,1]
    v_pk_fma_f32 v[158:159], v[28:29], v[32:33], v[158:159] op_sel:[0,0,0] op_sel_hi:[0,1,1]
    v_pk_fma_f32 v[160:161], v[28:29], v[34:35], v[160:161] op_sel:[0,0,0] op_sel_hi:[0,1,1]
    buffer_store_dwordx4 v[158:161], v30, s[68:71], 0 offen sc1
    s_waitcnt lgkmcnt(4)
    s_nop 0
    v_pk_add_f32 v[36:37], v[36:37], v[174:175]
    v_pk_add_f32 v[38:39], v[38:39], v[176:177]
    v_pk_add_f32 v[36:37], v[36:37], v[178:179]
    v_pk_add_f32 v[38:39], v[38:39], v[180:181]
    v_pk_add_f32 v[36:37], v[36:37], v[182:183]
    v_pk_add_f32 v[38:39], v[38:39], v[184:185]
    v_pk_add_f32 v[36:37], v[36:37], v[186:187]
    v_pk_add_f32 v[38:39], v[38:39], v[188:189]
    s_waitcnt lgkmcnt(0)
    s_nop 0
    v_pk_add_f32 v[190:191], v[190:191], v[194:195]
    v_pk_add_f32 v[192:193], v[192:193], v[196:197]
    v_pk_add_f32 v[190:191], v[190:191], v[230:231]
    v_pk_add_f32 v[192:193], v[192:193], v[232:233]
    v_pk_add_f32 v[190:191], v[190:191], v[234:235]
    v_pk_add_f32 v[192:193], v[192:193], v[236:237]
    v_pk_add_f32 v[36:37], v[36:37], v[190:191] neg_lo:[0,1] neg_hi:[0,1]
    v_pk_add_f32 v[38:39], v[38:39], v[192:193] neg_lo:[0,1] neg_hi:[0,1]
    v_pk_fma_f32 v[190:191], v[28:29], v[36:37], v[190:191] op_sel:[1,0,0] op_sel_hi:[1,1,1]
    v_pk_fma_f32 v[192:193], v[28:29], v[38:39], v[192:193] op_sel:[1,0,0] op_sel_hi:[1,1,1]
    buffer_store_dwordx4 v[190:193], v30, s[68:71], s23 offen sc1
    s_cmp_eq_u32 s2, 255
    s_cbranch_scc0 L_noepo
    s_mov_b32 s85, 0x6f0000
    s_mov_b64 exec, 1
    buffer_store_dwordx2 v[58:59], v21, s[64:67], s85 offen offset:0 sc1
    s_mov_b64 exec, -1
L_noepo:
    s_endpgm
L_Q_wq_r:
    s_waitcnt lgkmcnt(0)
    s_cmp_eq_u32 s88, 0
    s_cbranch_scc1 L_Q_wq_d
    s_sub_u32 s88, s88, 1
    s_branch L_Q_wq
L_Q_rf_r:
    s_waitcnt lgkmcnt(0)
    s_cmp_eq_u32 s88, 0
    s_cbranch_scc1 L_Q_rf_d
    s_sub_u32 s88, s88, 1
    s_branch L_Q_rf
L_Q_go_r:
    s_waitcnt lgkmcnt(0)
    s_cmp_eq_u32 s88, 0
    s_cbranch_scc1 L_Q_go_d
    s_sub_u32 s88, s88, 1
    s_sleep 2
    s_branch L_Q_go
L_QS_go_r:
    s_waitcnt lgkmcnt(0)
    s_cmp_eq_u32 s88, 0
    s_cbranch_scc1 L_QS_go_d
    s_sub_u32 s88, s88, 1
    s_sleep 1
    s_branch L_QS_go
L_Q_qd_r:
    s_waitcnt lgkmcnt(0)
    s_cmp_eq_u32 s88, 0
    s_cbranch_scc1 L_Q_qd_d
    s_sub_u32 s88, s88, 1
    s_branch L_Q_qd
L_Q_kp_r:
    s_cmp_eq_u32 s88, 0
    s_cbranch_scc1 L_Q_kp_d
    s_sub_u32 s88, s88, 1
    buffer_load_dwordx4 v[54:57], v15, s[64:67], s84 offen offset:1024 sc1
    s_waitcnt vmcnt(0)
    s_branch L_Q_kp
L_Q_kg_r:
    s_cmp_eq_u32 s88, 0
    s_cbranch_scc1 L_Q_kg_d
    s_sub_u32 s88, s88, 1
    s_nop 15
    s_waitcnt vmcnt(0) lgkmcnt(0)
    s_add_u32 s23, s84, 0
    buffer_load_dwordx4 v[94:97], v14, s[64:67], s23 offen offset:0 sc1
    buffer_load_dwordx4 v[98:101], v14, s[64:67], s23 offen offset:1152 sc1
    buffer_load_dwordx4 v[102:105], v14, s[64:67], s23 offen offset:2304 sc1
    buffer_load_dwordx4 v[106:109], v14, s[64:67], s23 offen offset:3456 sc1
    s_add_u32 s23, s84, 4608
    buffer_load_dwordx4 v[110:113], v14, s[64:67], s23 offen offset:0 sc1
    buffer_load_dwordx4 v[114:117], v14, s[64:67], s23 offen offset:1152 sc1
    buffer_load_dwordx4 v[118:121], v14, s[64:67], s23 offen offset:2304 sc1
    buffer_load_dwordx4 v[122:125], v14, s[64:67], s23 offen offset:3456 sc1
    s_add_u32 s23, s84, 9216
    buffer_load_dwordx4 v[126:129], v14, s[64:67], s23 offen offset:0 sc1
    buffer_load_dwordx4 v[130:133], v14, s[64:67], s23 offen offset:1152 sc1
    buffer_load_dwordx4 v[134:137], v14, s[64:67], s23 offen offset:2304 sc1
    buffer_load_dwordx4 v[138:141], v14, s[64:67], s23 offen offset:3456 sc1
    s_add_u32 s23, s84, 13824
    buffer_load_dwordx4 v[142:145], v14, s[64:67], s23 offen offset:0 sc1
    buffer_load_dwordx4 v[146:149], v14, s[64:67], s23 offen offset:1152 sc1
    buffer_load_dwordx4 v[150:153], v14, s[64:67], s23 offen offset:2304 sc1
    buffer_load_dwordx4 v[154:157], v14, s[64:67], s23 offen offset:3456 sc1
    s_waitcnt vmcnt(0)
    s_branch L_Q_ksum
L_Q_ks_r:
    s_waitcnt lgkmcnt(0)
    s_cmp_eq_u32 s88, 0
    s_cbranch_scc1 L_Q_ks_d
    s_sub_u32 s88, s88, 1
    s_branch L_Q_ks
L_Q_g_r:
    s_cmp_eq_u32 s88, 0
    s_cbranch_scc1 L_Q_g_d
    s_sub_u32 s88, s88, 1
    buffer_load_dword v28, v31, s[64:67], s79 offen offset:0 sc1
    buffer_load_dword v29, v31, s[64:67], s79 offen offset:1024 sc1
    s_waitcnt vmcnt(0)
    s_branch L_Q_g
L_Q_op_r:
    s_cmp_eq_u32 s88, 0
    s_cbranch_scc1 L_Q_op_d
    s_sub_u32 s88, s88, 1
    buffer_load_dwordx4 v[54:57], v15, s[64:67], s38 offen sc1
    s_waitcnt vmcnt(0)
    s_branch L_Q_op
L_Q_oa_r:
    s_cmp_eq_u32 s88, 0
    s_cbranch_scc1 L_Q_oa_d
    s_sub_u32 s88, s88, 1
    s_nop 15
    s_waitcnt vmcnt(0) lgkmcnt(0)
    s_add_u32 s23, s38, 8192
    buffer_load_dwordx4 v[6:9], v16, s[64:67], s23 offen offset:0 sc1
    buffer_load_dwordx4 v[10:13], v16, s[64:67], s23 offen offset:1024 sc1
    buffer_load_dwordx4 v[44:47], v16, s[64:67], s23 offen offset:2048 sc1
    buffer_load_dwordx4 v[48:51], v16, s[64:67], s23 offen offset:3072 sc1
    s_add_u32 s23, s38, 20480
    buffer_load_dwordx4 v[158:161], v16, s[64:67], s23 offen offset:0 sc1
    buffer_load_dwordx4 v[162:165], v16, s[64:67], s23 offen offset:1024 sc1
    buffer_load_dwordx4 v[166:169], v16, s[64:67], s23 offen offset:2048 sc1
    buffer_load_dwordx4 v[170:173], v16, s[64:67], s23 offen offset:3072 sc1
    s_waitcnt vmcnt(0)
    s_branch L_Q_oa
L_Q_ob_r:
    s_cmp_eq_u32 s88, 0
    s_cbranch_scc1 L_Q_ob_d
    s_sub_u32 s88, s88, 1
    s_nop 15
    s_waitcnt vmcnt(0) lgkmcnt(0)
    s_add_u32 s23, s38, 8192
    buffer_load_dwordx4 v[174:177], v14, s[64:67], s23 offen offset:0 sc1
    buffer_load_dwordx4 v[178:181], v14, s[64:67], s23 offen offset:1024 sc1
    buffer_load_dwordx4 v[182:185], v14, s[64:67], s23 offen offset:2048 sc1
    buffer_load_dwordx4 v[186:189], v14, s[64:67], s23 offen offset:3072 sc1
    s_add_u32 s23, s38, 20480
    buffer_load_dwordx4 v[190:193], v14, s[64:67], s23 offen offset:0 sc1
    buffer_load_dwordx4 v[194:197], v14, s[64:67], s23 offen offset:1024 sc1
    buffer_load_dwordx4 v[230:233], v14, s[64:67], s23 offen offset:2048 sc1
    buffer_load_dwordx4 v[234:237], v14, s[64:67], s23 offen offset:3072 sc1
    s_waitcnt vmcnt(0)
    s_branch L_Q_ob
.p2align 3
L_MKV:
    s_setprio 1
    s_and_b32 s85, s2, 7
    s_bfe_u32 s3, s2, 0x20003
    s_lshl_b32 s85, s85, 2
    s_add_u32 s80, s85, s3
    s_lshr_b32 s81, s2, 5
    s_mov_b64 s[64:65], s[36:37]
    s_mov_b32 s66, 0x6f1000
    s_mov_b32 s67, 0x20000
    s_mov_b32 s90, 0x3fb8aa3b
    s_mov_b32 s91, 0x3fb8aa3b
    s_mov_b32 s88, 200000
    s_mov_b32 s34, 0xffff
    s_mov_b32 s35, 0xffff
    v_mov_b32 v9, 133120
    v_lshl_add_u32 v22, s76, 2, v9
    v_mov_b32_e64 v23, 0
    s_mul_i32 s39, s87, 49152
    s_lshl_b32 s85, s86, 13
    s_add_u32 s39, s39, s85
    s_lshl_b32 s85, s77, 1
    s_add_u32 s85, s85, s87
    s_mul_i32 s38, s85, 196608
    s_mul_i32 s85, s78, 12288
    s_add_u32 s38, s38, s85
    s_lshr_b32 s84, s2, 3
    s_cmp_eq_u32 s76, 0
    s_cbranch_scc0 L_MKV_t1
    s_and_b32 s85, s2, 1
    s_lshl_b32 s85, s85, 2
    s_and_b32 s79, s2, 6
    s_xor_b32 s79, s79, s85
    s_add_u32 s79, s79, 2
    s_and_b32 s79, s79, 7
    v_lshrrev_b32 v3, 1, v7
    v_and_b32 v2, 1, v0
    v_mul_u32_u24 v3, 3072, v3
    v_lshl_add_u32 v2, v2, 10, v3
    s_lshl_b32 s79, s79, 2
    s_and_b32 s89, s84, 7
    s_add_u32 s85, s79, s89
    s_mul_i32 s85, s85, 49152
    s_lshl_b32 s89, s78, 7
    s_add_u32 s85, s85, s89
    s_add_u32 s85, s85, 1024
    s_mov_b64 s[44:45], s[24:25]
    s_branch L_MKV_t9
L_MKV_t1:
    s_cmp_eq_u32 s76, 1
    s_cbranch_scc0 L_MKV_t2
    v_lshlrev_b32 v2, 7, v7
    s_lshr_b32 s85, s2, 1
    s_lshl_b32 s85, s85, 12
    s_bitcmp1_b32 s2, 0
    s_cselect_b64 s[44:45], s[16:17], s[14:15]
    s_branch L_MKV_t9
L_MKV_t2:
    s_cmp_eq_u32 s76, 2
    s_cbranch_scc0 L_MKV_t3
    v_lshlrev_b32 v2, 6, v7
    s_lshl_b32 s85, s2, 11
    s_mov_b64 s[44:45], s[28:29]
    s_branch L_MKV_t9
L_MKV_t3:
    v_mul_u32_u24 v2, 3072, v7
    s_and_b32 s85, s84, 15
    s_mul_i32 s85, s85, 98304
    s_lshl_b32 s89, s78, 7
    s_add_u32 s85, s85, s89
    s_mov_b64 s[44:45], s[24:25]
L_MKV_t9:
    v_add_u32 v24, s85, v2
    v_lshl_add_u32 v2, v0, 2, v9
    ds_write_b32 v2, v23
    v_bfe_u32 v2, v0, 1, 3
    v_xor_b32 v2, v2, v8
    v_lshlrev_b32 v2, 4, v2
    v_lshl_add_u32 v2, v7, 7, v2
    s_lshl_b32 s3, s87, 13
    v_xor_b32 v3, 0, v2
    v_add_u32 v25, s3, v3
    v_add_u32 v29, s39, v3
    v_xor_b32 v3, 32, v2
    v_add_u32 v26, s3, v3
    v_add_u32 v30, s39, v3
    v_xor_b32 v3, 64, v2
    v_add_u32 v27, s3, v3
    v_add_u32 v31, s39, v3
    v_xor_b32 v3, 96, v2
    v_add_u32 v28, s3, v3
    v_add_u32 v32, s39, v3
    v_bfe_u32 v2, v0, 2, 2
    v_lshl_add_u32 v3, v8, 3, v2
    v_and_b32 v4, 3, v0
    v_lshlrev_b32 v4, 3, v4
    v_and_b32_e64 v5, 16, v0
    v_lshl_add_u32 v4, v5, 1, v4
    v_lshl_add_u32 v3, v3, 7, v4
    v_and_b32 v4, 8, v0
    v_lshlrev_b32 v4, 3, v4
    v_xor_b32_e64 v33, v3, v4
    v_lshl_add_u32 v2, v8, 2, v2
    v_lshl_add_u32 v2, v2, 5, v5
    v_and_b32_e64 v4, 2, v0
    v_lshl_add_u32 v2, v4, 2, v2
    v_add_u32 v34, 131072, v2
    s_lshl_b32 s85, s86, 6
    s_lshl_b32 s3, s87, 5
    s_add_u32 s85, s85, s3
    s_add_u32 s85, s85, 49152
    v_xor_b32 v33, s85, v33
    s_lshl_b32 s85, s86, 1
    s_add_u32 s85, s85, s87
    v_lshl_add_u32 v34, s85, 9, v34
    v_xor_b32 v35, 512, v34
    v_bfe_i32 v36, v0, 2, 1
    v_and_b32 v36, 0x80008000, v36
    v_mov_b32 v37, 0x3f803f80
    s_lshl_b32 s85, s76, 12
    s_add_u32 s85, s85, 147456
    v_add_u32 v40, s85, v6
    v_xor_b32 v41, 0x2100, v40
    v_lshlrev_b32_e64 v3, 4, v7
    v_lshl_add_u32 v2, v8, 8, v3
    v_lshl_add_u32 v4, v8, 5, v3
    v_add_u32 v4, 768, v4
    v_cndmask_b32 v38, v4, v2, s[34:35]
    v_add_u32 v2, 512, v2
    v_add_u32_e64 v4, 64, v4
    v_cndmask_b32 v39, v4, v2, s[34:35]
    s_lshl_b32 s85, s78, 2
    s_lshl_b32 s3, s86, 1
    s_add_u32 s85, s85, s3
    s_add_u32 s85, s85, s87
    s_lshl_b32 s85, s85, 4
    s_add_u32 s85, s85, s77
    s_mul_i32 s85, s85, 1152
    s_add_u32 s84, s85, 0x600000
    v_bfe_u32 v2, v0, 3, 2
    v_bfe_u32 v3, v0, 1, 1
    v_lshl_add_u32 v2, v2, 1, v3
    v_bfe_u32 v3, v0, 2, 1
    v_xor_b32_e64 v4, v3, v8
    v_lshl_add_u32 v2, v4, 3, v2
    v_and_b32 v4, 1, v0
    v_lshlrev_b32 v4, 4, v4
    v_mov_b32 v5, 0x3f80
    v_lshlrev_b32_e64 v5, v4, v5
    v_cmp_eq_u32 s[94:95], 0, v2
    v_cmp_eq_u32 s[96:97], 1, v2
    s_nop 0
    v_cndmask_b32 v42, 0, v5, s[94:95]
    v_cndmask_b32 v43, 0, v5, s[96:97]
    v_cmp_eq_u32 s[94:95], 2, v2
    v_cmp_eq_u32 s[96:97], 3, v2
    s_nop 0
    v_cndmask_b32 v44, 0, v5, s[94:95]
    v_cndmask_b32 v45, 0, v5, s[96:97]
    v_cmp_eq_u32 s[94:95], 4, v2
    v_cmp_eq_u32 s[96:97], 5, v2
    s_nop 0
    v_cndmask_b32 v46, 0, v5, s[94:95]
    v_cndmask_b32 v47, 0, v5, s[96:97]
    v_cmp_eq_u32 s[94:95], 6, v2
    v_cmp_eq_u32 s[96:97], 7, v2
    s_nop 0
    v_cndmask_b32 v48, 0, v5, s[94:95]
    v_cndmask_b32 v49, 0, v5, s[96:97]
    v_xor_b32 v50, 8, v22
    s_cmp_lg_u32 s87, 0
    s_cselect_b64 s[94:95], -1, 0
    s_mov_b32 s96, 0
    s_mov_b32 s97, -1
    s_mov_b32 s83, 0xffffff00
    s_waitcnt lgkmcnt(0)
    s_add_u32 s0, s0, 0x9e3779b1
    s_mov_b32 s1, s0
    v_mov_b32 v52, s0
    v_mov_b32_e64 v53, s0
    v_and_b32 v51, 0xff, v52
    s_and_b32 s30, s0, 1
    s_xor_b32 s31, s30, 1
    s_mul_i32 s85, s86, 98304
    s_add_u32 s85, s85, s38
    s_add_u32 s85, s85, 10112
    v_mov_b32 v54, s85
    s_add_u32 s85, s84, 1024
    v_writelane_b32 v54, s85, 1
    s_mov_b64 exec, 7
    buffer_load_dword v54, v54, s[64:67], 0 offen
    s_mov_b64 exec, -1
    s_lshl_b32 s85, s81, 7
    v_mov_b32 v55, s85
    global_load_dword v55, v55, s[20:21]
    s_barrier
    ds_read_b64_tr_b16 v[56:57], v34 offset:0
    ds_read_b64_tr_b16 v[58:59], v34 offset:256
    ds_read_b64_tr_b16 v[60:61], v35 offset:0
    ds_read_b64_tr_b16 v[62:63], v35 offset:256
    ds_read_b128 v[128:131], v25 offset:0
    ds_read_b64_tr_b16 v[136:137], v33 offset:0
    ds_read_b64_tr_b16 v[138:139], v33 offset:512
    ds_read_b128 v[132:135], v25 offset:4096
    ds_read_b64_tr_b16 v[140:141], v33 offset:8192
    ds_read_b64_tr_b16 v[142:143], v33 offset:8704
    ds_read_b128 v[144:147], v26 offset:0
    ds_read_b64_tr_b16 v[152:153], v33 offset:2048
    ds_read_b64_tr_b16 v[154:155], v33 offset:2560
    ds_read_b128 v[148:151], v26 offset:4096
    ds_read_b64_tr_b16 v[156:157], v33 offset:10240
    ds_read_b64_tr_b16 v[158:159], v33 offset:10752
    s_mov_b32 exec_hi, 0
    global_load_dword v24, v24, s[44:45]
    s_mov_b64 exec, -1
L_MKV_ti15:
    s_waitcnt lgkmcnt(6)
    v_mfma_f32_32x32x16_bf16 v[64:79], v[136:139], v[128:131], 0
    v_mfma_f32_32x32x16_bf16 v[80:95], v[136:139], v[132:135], 0
    v_mfma_f32_32x32x16_bf16 v[96:111], v[128:131], v[140:143], 0
    v_mfma_f32_32x32x16_bf16 v[112:127], v[132:135], v[140:143], 0
    ds_read_b128 v[128:131], v27 offset:0
    ds_read_b64_tr_b16 v[136:137], v33 offset:4096
    ds_read_b64_tr_b16 v[138:139], v33 offset:4608
    ds_read_b128 v[132:135], v27 offset:4096
    ds_read_b64_tr_b16 v[140:141], v33 offset:12288
    ds_read_b64_tr_b16 v[142:143], v33 offset:12800
    s_waitcnt lgkmcnt(6)
    v_xor_b32 v56, v36, v56
    v_mfma_f32_32x32x16_bf16 v[64:79], v[152:155], v[144:147], v[64:79]
    v_xor_b32 v57, v36, v57
    v_xor_b32 v58, v36, v58
    v_mfma_f32_32x32x16_bf16 v[80:95], v[152:155], v[148:151], v[80:95]
    v_xor_b32 v59, v36, v59
    v_xor_b32 v60, v36, v60
    v_mfma_f32_32x32x16_bf16 v[96:111], v[144:147], v[156:159], v[96:111]
    v_xor_b32 v61, v36, v61
    v_xor_b32 v62, v36, v62
    v_mfma_f32_32x32x16_bf16 v[112:127], v[148:151], v[156:159], v[112:127]
    v_xor_b32_e64 v63, v36, v63
    ds_read_b128 v[144:147], v28 offset:0
    ds_read_b64_tr_b16 v[152:153], v33 offset:6144
    ds_read_b64_tr_b16 v[154:155], v33 offset:6656
    ds_read_b128 v[148:151], v28 offset:4096
    ds_read_b64_tr_b16 v[156:157], v33 offset:14336
    ds_read_b64_tr_b16 v[158:159], v33 offset:14848
    s_waitcnt lgkmcnt(6)
    v_mfma_f32_32x32x16_bf16 v[64:79], v[136:139], v[128:131], v[64:79]
    v_mfma_f32_32x32x16_bf16 v[80:95], v[136:139], v[132:135], v[80:95]
    v_mfma_f32_32x32x16_bf16 v[96:111], v[128:131], v[140:143], v[96:111]
    v_mfma_f32_32x32x16_bf16 v[112:127], v[132:135], v[140:143], v[112:127]
    s_waitcnt lgkmcnt(0)
    s_barrier
    ds_read_b128 v[128:131], v25 offset:16384
    ds_read_b64_tr_b16 v[136:137], v33 offset:16384
    ds_read_b64_tr_b16 v[138:139], v33 offset:16896
    ds_read_b128 v[132:135], v25 offset:20480
    ds_read_b64_tr_b16 v[140:141], v33 offset:24576
    ds_read_b64_tr_b16 v[142:143], v33 offset:25088
    v_mfma_f32_32x32x16_bf16 v[64:79], v[152:155], v[144:147], v[64:79]
    v_mfma_f32_32x32x16_bf16 v[80:95], v[152:155], v[148:151], v[80:95]
    v_mfma_f32_32x32x16_bf16 v[96:111], v[144:147], v[156:159], v[96:111]
    v_mfma_f32_32x32x16_bf16 v[112:127], v[148:151], v[156:159], v[112:127]
    ds_read_b128 v[144:147], v26 offset:16384
    ds_read_b64_tr_b16 v[152:153], v33 offset:18432
    ds_read_b64_tr_b16 v[154:155], v33 offset:18944
    ds_read_b128 v[148:151], v26 offset:20480
    ds_read_b64_tr_b16 v[156:157], v33 offset:26624
    ds_read_b64_tr_b16 v[158:159], v33 offset:27136
    s_waitcnt lgkmcnt(6)
    v_mfma_f32_32x32x16_bf16 v[64:79], v[136:139], v[128:131], v[64:79]
    v_mfma_f32_32x32x16_bf16 v[80:95], v[136:139], v[132:135], v[80:95]
    v_mfma_f32_32x32x16_bf16 v[96:111], v[128:131], v[140:143], v[96:111]
    v_mfma_f32_32x32x16_bf16 v[112:127], v[132:135], v[140:143], v[112:127]
    ds_read_b128 v[128:131], v27 offset:16384
    ds_read_b64_tr_b16 v[136:137], v33 offset:20480
    ds_read_b64_tr_b16 v[138:139], v33 offset:20992
    ds_read_b128 v[132:135], v27 offset:20480
    ds_read_b64_tr_b16 v[140:141], v33 offset:28672
    ds_read_b64_tr_b16 v[142:143], v33 offset:29184
    s_waitcnt lgkmcnt(6)
    v_mfma_f32_32x32x16_bf16 v[64:79], v[152:155], v[144:147], v[64:79]
    v_mfma_f32_32x32x16_bf16 v[80:95], v[152:155], v[148:151], v[80:95]
    v_mfma_f32_32x32x16_bf16 v[96:111], v[144:147], v[156:159], v[96:111]
    v_mfma_f32_32x32x16_bf16 v[112:127], v[148:151], v[156:159], v[112:127]
    ds_read_b128 v[144:147], v28 offset:16384
    ds_read_b64_tr_b16 v[152:153], v33 offset:22528
    ds_read_b64_tr_b16 v[154:155], v33 offset:23040
    ds_read_b128 v[148:151], v28 offset:20480
    ds_read_b64_tr_b16 v[156:157], v33 offset:30720
    ds_read_b64_tr_b16 v[158:159], v33 offset:31232
    s_waitcnt lgkmcnt(6)
    v_mfma_f32_32x32x16_bf16 v[64:79], v[136:139], v[128:131], v[64:79]
    v_mfma_f32_32x32x16_bf16 v[80:95], v[136:139], v[132:135], v[80:95]
    v_mfma_f32_32x32x16_bf16 v[96:111], v[128:131], v[140:143], v[96:111]
    v_mfma_f32_32x32x16_bf16 v[112:127], v[132:135], v[140:143], v[112:127]
    s_waitcnt lgkmcnt(0)
    s_barrier
    ds_read_b128 v[128:131], v25 offset:32768
    ds_read_b64_tr_b16 v[136:137], v33 offset:32768
    ds_read_b64_tr_b16 v[138:139], v33 offset:33280
    ds_read_b128 v[132:135], v25 offset:36864
    ds_read_b64_tr_b16 v[140:141], v33 offset:40960
    ds_read_b64_tr_b16 v[142:143], v33 offset:41472
    v_mfma_f32_32x32x16_bf16 v[64:79], v[152:155], v[144:147], v[64:79]
    v_mfma_f32_32x32x16_bf16 v[80:95], v[152:155], v[148:151], v[80:95]
    v_mfma_f32_32x32x16_bf16 v[96:111], v[144:147], v[156:159], v[96:111]
    v_mfma_f32_32x32x16_bf16 v[112:127], v[148:151], v[156:159], v[112:127]
    ds_read_b128 v[144:147], v26 offset:32768
    ds_read_b64_tr_b16 v[152:153], v33 offset:34816
    ds_read_b64_tr_b16 v[154:155], v33 offset:35328
    ds_read_b128 v[148:151], v26 offset:36864
    ds_read_b64_tr_b16 v[156:157], v33 offset:43008
    ds_read_b64_tr_b16 v[158:159], v33 offset:43520
    s_waitcnt lgkmcnt(6)
    v_mfma_f32_32x32x16_bf16 v[64:79], v[136:139], v[128:131], v[64:79]
    v_mfma_f32_32x32x16_bf16 v[80:95], v[136:139], v[132:135], v[80:95]
    v_mfma_f32_32x32x16_bf16 v[96:111], v[128:131], v[140:143], v[96:111]
    v_mfma_f32_32x32x16_bf16 v[112:127], v[132:135], v[140:143], v[112:127]
    ds_read_b128 v[128:131], v27 offset:32768
    ds_read_b64_tr_b16 v[136:137], v33 offset:36864
    ds_read_b64_tr_b16 v[138:139], v33 offset:37376
    ds_read_b128 v[132:135], v27 offset:36864
    ds_read_b64_tr_b16 v[140:141], v33 offset:45056
    ds_read_b64_tr_b16 v[142:143], v33 offset:45568
    s_waitcnt lgkmcnt(6)
    v_mfma_f32_32x32x16_bf16 v[64:79], v[152:155], v[144:147], v[64:79]
    v_mfma_f32_32x32x16_bf16 v[80:95], v[152:155], v[148:151], v[80:95]
    v_mfma_f32_32x32x16_bf16 v[96:111], v[144:147], v[156:159], v[96:111]
    v_mfma_f32_32x32x16_bf16 v[112:127], v[148:151], v[156:159], v[112:127]
    ds_read_b128 v[144:147], v28 offset:32768
    ds_read_b64_tr_b16 v[152:153], v33 offset:38912
    ds_read_b64_tr_b16 v[154:155], v33 offset:39424
    ds_read_b128 v[148:151], v28 offset:36864
    ds_read_b64_tr_b16 v[156:157], v33 offset:47104
    ds_read_b64_tr_b16 v[158:159], v33 offset:47616
    s_waitcnt lgkmcnt(6)
    v_mfma_f32_32x32x16_bf16 v[64:79], v[136:139], v[128:131], v[64:79]
    v_mfma_f32_32x32x16_bf16 v[80:95], v[136:139], v[132:135], v[80:95]
    v_mfma_f32_32x32x16_bf16 v[96:111], v[128:131], v[140:143], v[96:111]
    v_mfma_f32_32x32x16_bf16 v[112:127], v[132:135], v[140:143], v[112:127]
    s_waitcnt lgkmcnt(0)
    s_barrier
    ds_read_b128 v[128:131], v25 offset:0
    ds_read_b64_tr_b16 v[136:137], v33 offset:0
    ds_read_b64_tr_b16 v[138:139], v33 offset:512
    ds_read_b128 v[132:135], v25 offset:4096
    ds_read_b64_tr_b16 v[140:141], v33 offset:8192
    ds_read_b64_tr_b16 v[142:143], v33 offset:8704
    v_mfma_f32_32x32x16_bf16 v[64:79], v[152:155], v[144:147], v[64:79]
    v_mfma_f32_32x32x16_bf16 v[80:95], v[152:155], v[148:151], v[80:95]
    v_mfma_f32_32x32x16_bf16 v[96:111], v[144:147], v[156:159], v[96:111]
    v_mfma_f32_32x32x16_bf16 v[112:127], v[148:151], v[156:159], v[112:127]
    ds_read_b128 v[144:147], v26 offset:0
    ds_read_b64_tr_b16 v[152:153], v33 offset:2048
    ds_read_b64_tr_b16 v[154:155], v33 offset:2560
    ds_read_b128 v[148:151], v26 offset:4096
    ds_read_b64_tr_b16 v[156:157], v33 offset:10240
    ds_read_b64_tr_b16 v[158:159], v33 offset:10752
    s_waitcnt lgkmcnt(6)
    v_mfma_f32_32x32x16_bf16 v[64:79], v[136:139], v[128:131], v[64:79]
    v_mfma_f32_32x32x16_bf16 v[80:95], v[136:139], v[132:135], v[80:95]
    v_mfma_f32_32x32x16_bf16 v[96:111], v[128:131], v[140:143], v[96:111]
    v_mfma_f32_32x32x16_bf16 v[112:127], v[132:135], v[140:143], v[112:127]
    ds_read_b128 v[128:131], v27 offset:0
    ds_read_b64_tr_b16 v[136:137], v33 offset:4096
    ds_read_b64_tr_b16 v[138:139], v33 offset:4608
    ds_read_b128 v[132:135], v27 offset:4096
    ds_read_b64_tr_b16 v[140:141], v33 offset:12288
    ds_read_b64_tr_b16 v[142:143], v33 offset:12800
    s_waitcnt lgkmcnt(6)
    v_mfma_f32_32x32x16_bf16 v[64:79], v[152:155], v[144:147], v[64:79]
    v_mfma_f32_32x32x16_bf16 v[80:95], v[152:155], v[148:151], v[80:95]
    v_mfma_f32_32x32x16_bf16 v[96:111], v[144:147], v[156:159], v[96:111]
    v_mfma_f32_32x32x16_bf16 v[112:127], v[148:151], v[156:159], v[112:127]
    ds_read_b128 v[144:147], v28 offset:0
    ds_read_b64_tr_b16 v[152:153], v33 offset:6144
    ds_read_b64_tr_b16 v[154:155], v33 offset:6656
    ds_read_b128 v[148:151], v28 offset:4096
    ds_read_b64_tr_b16 v[156:157], v33 offset:14336
    ds_read_b64_tr_b16 v[158:159], v33 offset:14848
    s_waitcnt lgkmcnt(6)
    v_mfma_f32_32x32x16_bf16 v[64:79], v[136:139], v[128:131], v[64:79]
    v_mfma_f32_32x32x16_bf16 v[80:95], v[136:139], v[132:135], v[80:95]
    v_mfma_f32_32x32x16_bf16 v[96:111], v[128:131], v[140:143], v[96:111]
    v_mfma_f32_32x32x16_bf16 v[112:127], v[132:135], v[140:143], v[112:127]
    s_waitcnt lgkmcnt(0)
    s_barrier
    ds_read_b128 v[128:131], v25 offset:16384
    ds_read_b64_tr_b16 v[136:137], v33 offset:16384
    ds_read_b64_tr_b16 v[138:139], v33 offset:16896
    ds_read_b128 v[132:135], v25 offset:20480
    ds_read_b64_tr_b16 v[140:141], v33 offset:24576
    ds_read_b64_tr_b16 v[142:143], v33 offset:25088
    v_mfma_f32_32x32x16_bf16 v[64:79], v[152:155], v[144:147], v[64:79]
    v_mfma_f32_32x32x16_bf16 v[80:95], v[152:155], v[148:151], v[80:95]
    v_mfma_f32_32x32x16_bf16 v[96:111], v[144:147], v[156:159], v[96:111]
    v_mfma_f32_32x32x16_bf16 v[112:127], v[148:151], v[156:159], v[112:127]
    ds_read_b128 v[144:147], v26 offset:16384
    ds_read_b64_tr_b16 v[152:153], v33 offset:18432
    ds_read_b64_tr_b16 v[154:155], v33 offset:18944
    ds_read_b128 v[148:151], v26 offset:20480
    ds_read_b64_tr_b16 v[156:157], v33 offset:26624
    ds_read_b64_tr_b16 v[158:159], v33 offset:27136
    s_waitcnt lgkmcnt(6)
    v_mfma_f32_32x32x16_bf16 v[64:79], v[136:139], v[128:131], v[64:79]
    v_mfma_f32_32x32x16_bf16 v[80:95], v[136:139], v[132:135], v[80:95]
    v_mfma_f32_32x32x16_bf16 v[96:111], v[128:131], v[140:143], v[96:111]
    v_mfma_f32_32x32x16_bf16 v[112:127], v[132:135], v[140:143], v[112:127]
    ds_read_b128 v[128:131], v27 offset:16384
    ds_read_b64_tr_b16 v[136:137], v33 offset:20480
    ds_read_b64_tr_b16 v[138:139], v33 offset:20992
    ds_read_b128 v[132:135], v27 offset:20480
    ds_read_b64_tr_b16 v[140:141], v33 offset:28672
    ds_read_b64_tr_b16 v[142:143], v33 offset:29184
    s_waitcnt lgkmcnt(6)
    v_mfma_f32_32x32x16_bf16 v[64:79], v[152:155], v[144:147], v[64:79]
    v_mfma_f32_32x32x16_bf16 v[80:95], v[152:155], v[148:151], v[80:95]
    v_mfma_f32_32x32x16_bf16 v[96:111], v[144:147], v[156:159], v[96:111]
    v_mfma_f32_32x32x16_bf16 v[112:127], v[148:151], v[156:159], v[112:127]
    ds_read_b128 v[144:147], v28 offset:16384
    ds_read_b64_tr_b16 v[152:153], v33 offset:22528
    ds_read_b64_tr_b16 v[154:155], v33 offset:23040
    ds_read_b128 v[148:151], v28 offset:20480
    ds_read_b64_tr_b16 v[156:157], v33 offset:30720
    ds_read_b64_tr_b16 v[158:159], v33 offset:31232
    s_waitcnt lgkmcnt(6)
    v_mfma_f32_32x32x16_bf16 v[64:79], v[136:139], v[128:131], v[64:79]
    v_mfma_f32_32x32x16_bf16 v[80:95], v[136:139], v[132:135], v[80:95]
    v_mfma_f32_32x32x16_bf16 v[96:111], v[128:131], v[140:143], v[96:111]
    v_mfma_f32_32x32x16_bf16 v[112:127], v[132:135], v[140:143], v[112:127]
    s_waitcnt lgkmcnt(0)
    s_barrier
    ds_read_b128 v[128:131], v25 offset:32768
    ds_read_b64_tr_b16 v[136:137], v33 offset:32768
    ds_read_b64_tr_b16 v[138:139], v33 offset:33280
    ds_read_b128 v[132:135], v25 offset:36864
    ds_read_b64_tr_b16 v[140:141], v33 offset:40960
    ds_read_b64_tr_b16 v[142:143], v33 offset:41472
    v_mfma_f32_32x32x16_bf16 v[64:79], v[152:155], v[144:147], v[64:79]
    v_mfma_f32_32x32x16_bf16 v[80:95], v[152:155], v[148:151], v[80:95]
    v_mfma_f32_32x32x16_bf16 v[96:111], v[144:147], v[156:159], v[96:111]
    v_mfma_f32_32x32x16_bf16 v[112:127], v[148:151], v[156:159], v[112:127]
    ds_read_b128 v[144:147], v26 offset:32768
    ds_read_b64_tr_b16 v[152:153], v33 offset:34816
    ds_read_b64_tr_b16 v[154:155], v33 offset:35328
    ds_read_b128 v[148:151], v26 offset:36864
    ds_read_b64_tr_b16 v[156:157], v33 offset:43008
    ds_read_b64_tr_b16 v[158:159], v33 offset:43520
    s_waitcnt lgkmcnt(6)
    v_mfma_f32_32x32x16_bf16 v[64:79], v[136:139], v[128:131], v[64:79]
    v_mfma_f32_32x32x16_bf16 v[80:95], v[136:139], v[132:135], v[80:95]
    v_mfma_f32_32x32x16_bf16 v[96:111], v[128:131], v[140:143], v[96:111]
    v_mfma_f32_32x32x16_bf16 v[112:127], v[132:135], v[140:143], v[112:127]
    ds_read_b128 v[128:131], v27 offset:32768
    ds_read_b64_tr_b16 v[136:137], v33 offset:36864
    ds_read_b64_tr_b16 v[138:139], v33 offset:37376
    ds_read_b128 v[132:135], v27 offset:36864
    ds_read_b64_tr_b16 v[140:141], v33 offset:45056
    ds_read_b64_tr_b16 v[142:143], v33 offset:45568
    s_waitcnt lgkmcnt(6)
    v_mfma_f32_32x32x16_bf16 v[64:79], v[152:155], v[144:147], v[64:79]
    v_mfma_f32_32x32x16_bf16 v[80:95], v[152:155], v[148:151], v[80:95]
    v_mfma_f32_32x32x16_bf16 v[96:111], v[144:147], v[156:159], v[96:111]
    v_mfma_f32_32x32x16_bf16 v[112:127], v[148:151], v[156:159], v[112:127]
    ds_read_b128 v[144:147], v28 offset:32768
    ds_read_b64_tr_b16 v[152:153], v33 offset:38912
    ds_read_b64_tr_b16 v[154:155], v33 offset:39424
    ds_read_b128 v[148:151], v28 offset:36864
    ds_read_b64_tr_b16 v[156:157], v33 offset:47104
    ds_read_b64_tr_b16 v[158:159], v33 offset:47616
    s_waitcnt lgkmcnt(6)
    v_mfma_f32_32x32x16_bf16 v[64:79], v[136:139], v[128:131], v[64:79]
    v_mfma_f32_32x32x16_bf16 v[80:95], v[136:139], v[132:135], v[80:95]
    v_mfma_f32_32x32x16_bf16 v[96:111], v[128:131], v[140:143], v[96:111]
    v_mfma_f32_32x32x16_bf16 v[112:127], v[132:135], v[140:143], v[112:127]
    s_waitcnt lgkmcnt(0)
    s_barrier
    ds_read_b128 v[128:131], v25 offset:0
    ds_read_b64_tr_b16 v[136:137], v33 offset:0
    ds_read_b64_tr_b16 v[138:139], v33 offset:512
    ds_read_b128 v[132:135], v25 offset:4096
    ds_read_b64_tr_b16 v[140:141], v33 offset:8192
    ds_read_b64_tr_b16 v[142:143], v33 offset:8704
    v_mfma_f32_32x32x16_bf16 v[64:79], v[152:155], v[144:147], v[64:79]
    v_mfma_f32_32x32x16_bf16 v[80:95], v[152:155], v[148:151], v[80:95]
    v_mfma_f32_32x32x16_bf16 v[96:111], v[144:147], v[156:159], v[96:111]
    v_mfma_f32_32x32x16_bf16 v[112:127], v[148:151], v[156:159], v[112:127]
    ds_read_b128 v[144:147], v26 offset:0
    ds_read_b64_tr_b16 v[152:153], v33 offset:2048
    ds_read_b64_tr_b16 v[154:155], v33 offset:2560
    ds_read_b128 v[148:151], v26 offset:4096
    ds_read_b64_tr_b16 v[156:157], v33 offset:10240
    ds_read_b64_tr_b16 v[158:159], v33 offset:10752
    s_waitcnt lgkmcnt(6)
    v_mfma_f32_32x32x16_bf16 v[64:79], v[136:139], v[128:131], v[64:79]
    v_mfma_f32_32x32x16_bf16 v[80:95], v[136:139], v[132:135], v[80:95]
    v_mfma_f32_32x32x16_bf16 v[96:111], v[128:131], v[140:143], v[96:111]
    v_mfma_f32_32x32x16_bf16 v[112:127], v[132:135], v[140:143], v[112:127]
    ds_read_b128 v[128:131], v27 offset:0
    ds_read_b64_tr_b16 v[136:137], v33 offset:4096
    ds_read_b64_tr_b16 v[138:139], v33 offset:4608
    ds_read_b128 v[132:135], v27 offset:4096
    ds_read_b64_tr_b16 v[140:141], v33 offset:12288
    ds_read_b64_tr_b16 v[142:143], v33 offset:12800
    s_waitcnt lgkmcnt(6)
    v_mfma_f32_32x32x16_bf16 v[64:79], v[152:155], v[144:147], v[64:79]
    v_mfma_f32_32x32x16_bf16 v[80:95], v[152:155], v[148:151], v[80:95]
    v_mfma_f32_32x32x16_bf16 v[96:111], v[144:147], v[156:159], v[96:111]
    v_mfma_f32_32x32x16_bf16 v[112:127], v[148:151], v[156:159], v[112:127]
    ds_read_b128 v[144:147], v28 offset:0
    ds_read_b64_tr_b16 v[152:153], v33 offset:6144
    ds_read_b64_tr_b16 v[154:155], v33 offset:6656
    ds_read_b128 v[148:151], v28 offset:4096
    ds_read_b64_tr_b16 v[156:157], v33 offset:14336
    ds_read_b64_tr_b16 v[158:159], v33 offset:14848
    s_waitcnt lgkmcnt(6)
    v_mfma_f32_32x32x16_bf16 v[64:79], v[136:139], v[128:131], v[64:79]
    v_mfma_f32_32x32x16_bf16 v[80:95], v[136:139], v[132:135], v[80:95]
    v_mfma_f32_32x32x16_bf16 v[96:111], v[128:131], v[140:143], v[96:111]
    v_mfma_f32_32x32x16_bf16 v[112:127], v[132:135], v[140:143], v[112:127]
    s_waitcnt lgkmcnt(0)
    s_barrier
    ds_read_b128 v[128:131], v25 offset:16384
    ds_read_b64_tr_b16 v[136:137], v33 offset:16384
    ds_read_b64_tr_b16 v[138:139], v33 offset:16896
    ds_read_b128 v[132:135], v25 offset:20480
    ds_read_b64_tr_b16 v[140:141], v33 offset:24576
    ds_read_b64_tr_b16 v[142:143], v33 offset:25088
    v_mfma_f32_32x32x16_bf16 v[64:79], v[152:155], v[144:147], v[64:79]
    v_mfma_f32_32x32x16_bf16 v[80:95], v[152:155], v[148:151], v[80:95]
    v_mfma_f32_32x32x16_bf16 v[96:111], v[144:147], v[156:159], v[96:111]
    v_mfma_f32_32x32x16_bf16 v[112:127], v[148:151], v[156:159], v[112:127]
    ds_read_b128 v[144:147], v26 offset:16384
    ds_read_b64_tr_b16 v[152:153], v33 offset:18432
    ds_read_b64_tr_b16 v[154:155], v33 offset:18944
    ds_read_b128 v[148:151], v26 offset:20480
    ds_read_b64_tr_b16 v[156:157], v33 offset:26624
    ds_read_b64_tr_b16 v[158:159], v33 offset:27136
    s_waitcnt lgkmcnt(6)
    v_mfma_f32_32x32x16_bf16 v[64:79], v[136:139], v[128:131], v[64:79]
    v_mfma_f32_32x32x16_bf16 v[80:95], v[136:139], v[132:135], v[80:95]
    v_mfma_f32_32x32x16_bf16 v[96:111], v[128:131], v[140:143], v[96:111]
    v_mfma_f32_32x32x16_bf16 v[112:127], v[132:135], v[140:143], v[112:127]
    ds_read_b128 v[128:131], v27 offset:16384
    ds_read_b64_tr_b16 v[136:137], v33 offset:20480
    ds_read_b64_tr_b16 v[138:139], v33 offset:20992
    ds_read_b128 v[132:135], v27 offset:20480
    ds_read_b64_tr_b16 v[140:141], v33 offset:28672
    ds_read_b64_tr_b16 v[142:143], v33 offset:29184
    s_waitcnt lgkmcnt(6)
    v_mfma_f32_32x32x16_bf16 v[64:79], v[152:155], v[144:147], v[64:79]
    v_mfma_f32_32x32x16_bf16 v[80:95], v[152:155], v[148:151], v[80:95]
    v_mfma_f32_32x32x16_bf16 v[96:111], v[144:147], v[156:159], v[96:111]
    v_mfma_f32_32x32x16_bf16 v[112:127], v[148:151], v[156:159], v[112:127]
    ds_read_b128 v[144:147], v28 offset:16384
    ds_read_b64_tr_b16 v[152:153], v33 offset:22528
    ds_read_b64_tr_b16 v[154:155], v33 offset:23040
    ds_read_b128 v[148:151], v28 offset:20480
    ds_read_b64_tr_b16 v[156:157], v33 offset:30720
    ds_read_b64_tr_b16 v[158:159], v33 offset:31232
    s_waitcnt lgkmcnt(6)
    v_mfma_f32_32x32x16_bf16 v[64:79], v[136:139], v[128:131], v[64:79]
    v_mfma_f32_32x32x16_bf16 v[80:95], v[136:139], v[132:135], v[80:95]
    v_mfma_f32_32x32x16_bf16 v[96:111], v[128:131], v[140:143], v[96:111]
    v_mfma_f32_32x32x16_bf16 v[112:127], v[132:135], v[140:143], v[112:127]
    s_waitcnt lgkmcnt(0)
    s_mov_b64 exec, 1
    ds_write_b32 v22, v9 offset:0
    s_mov_b64 exec, -1
    v_mfma_f32_32x32x16_bf16 v[64:79], v[152:155], v[144:147], v[64:79]
    v_mfma_f32_32x32x16_bf16 v[80:95], v[152:155], v[148:151], v[80:95]
    v_mfma_f32_32x32x16_bf16 v[96:111], v[144:147], v[156:159], v[96:111]
    v_mfma_f32_32x32x16_bf16 v[112:127], v[148:151], v[156:159], v[112:127]
    s_nop 8
    v_cvt_pk_bf16_f32 v128, v64, v65
    v_cvt_pk_bf16_f32 v129, v66, v67
    v_cvt_pk_bf16_f32 v130, v68, v69
    v_cvt_pk_bf16_f32 v131, v70, v71
    v_cvt_pk_bf16_f32 v132, v72, v73
    v_cvt_pk_bf16_f32 v133, v74, v75
    v_cvt_pk_bf16_f32 v134, v76, v77
    v_cvt_pk_bf16_f32 v135, v78, v79
    v_cvt_pk_bf16_f32 v136, v80, v81
    v_cvt_pk_bf16_f32 v137, v82, v83
    v_cvt_pk_bf16_f32 v138, v84, v85
    v_cvt_pk_bf16_f32 v139, v86, v87
    v_cvt_pk_bf16_f32 v140, v88, v89
    v_cvt_pk_bf16_f32 v141, v90, v91
    v_cvt_pk_bf16_f32 v142, v92, v93
    v_cvt_pk_bf16_f32 v143, v94, v95
    v_mfma_f32_32x32x16_bf16 v[64:79], v[60:63], v[132:135], 0
    v_cvt_pk_bf16_f32 v144, v96, v97
    v_cvt_pk_bf16_f32 v145, v98, v99
    v_cvt_pk_bf16_f32 v146, v100, v101
    v_cvt_pk_bf16_f32 v147, v102, v103
    v_cvt_pk_bf16_f32 v148, v104, v105
    v_cvt_pk_bf16_f32 v149, v106, v107
    v_cvt_pk_bf16_f32 v150, v108, v109
    v_cvt_pk_bf16_f32 v151, v110, v111
    v_cvt_pk_bf16_f32 v152, v112, v113
    v_cvt_pk_bf16_f32 v153, v114, v115
    v_cvt_pk_bf16_f32 v154, v116, v117
    v_mfma_f32_32x32x16_bf16 v[80:95], v[60:63], v[140:143], 0
    v_cvt_pk_bf16_f32 v155, v118, v119
    v_cvt_pk_bf16_f32 v156, v120, v121
    v_cvt_pk_bf16_f32 v157, v122, v123
    v_cvt_pk_bf16_f32 v158, v124, v125
    v_cvt_pk_bf16_f32 v159, v126, v127
    v_cndmask_b32 v200, v37, v144, s[34:35]
    v_cndmask_b32 v144, v144, v37, s[34:35]
    v_cndmask_b32 v201, v37, v145, s[34:35]
    v_cndmask_b32 v145, v145, v37, s[34:35]
    v_cndmask_b32 v202, v37, v146, s[34:35]
    v_cndmask_b32 v146, v146, v37, s[34:35]
    v_mfma_f32_32x32x16_bf16 v[160:175], v[56:59], v[128:131], 0
    v_cndmask_b32 v203, v37, v147, s[34:35]
    v_cndmask_b32 v147, v147, v37, s[34:35]
    v_cndmask_b32 v204, v37, v148, s[34:35]
    v_cndmask_b32 v148, v148, v37, s[34:35]
    v_cndmask_b32 v205, v37, v149, s[34:35]
    v_cndmask_b32 v149, v149, v37, s[34:35]
    v_cndmask_b32 v206, v37, v150, s[34:35]
    v_cndmask_b32 v150, v150, v37, s[34:35]
    v_cndmask_b32 v207, v37, v151, s[34:35]
    v_cndmask_b32 v151, v151, v37, s[34:35]
    v_cndmask_b32 v208, v37, v152, s[34:35]
    v_mfma_f32_32x32x16_bf16 v[176:191], v[56:59], v[136:139], 0
    v_cndmask_b32 v152, v152, v37, s[34:35]
    v_cndmask_b32 v209, v37, v153, s[34:35]
    v_cndmask_b32 v153, v153, v37, s[34:35]
    v_cndmask_b32 v210, v37, v154, s[34:35]
    v_cndmask_b32 v154, v154, v37, s[34:35]
    v_cndmask_b32 v211, v37, v155, s[34:35]
    v_cndmask_b32 v155, v155, v37, s[34:35]
    v_cndmask_b32 v212, v37, v156, s[34:35]
    v_cndmask_b32 v156, v156, v37, s[34:35]
    v_cndmask_b32 v213, v37, v157, s[34:35]
    v_cndmask_b32 v157, v157, v37, s[34:35]
    v_cndmask_b32 v214, v37, v158, s[34:35]
    v_cndmask_b32 v158, v158, v37, s[34:35]
    v_cndmask_b32 v215, v37, v159, s[34:35]
    v_cndmask_b32 v159, v159, v37, s[34:35]
    v_max3_f32 v18, v64, v65, v66
    v_max3_f32 v18, v18, v67, v68
    v_max3_f32 v18, v18, v69, v70
    v_max3_f32 v18, v18, v71, v72
    v_max3_f32 v18, v18, v73, v74
    v_max3_f32 v18, v18, v75, v76
    v_max3_f32 v18, v18, v77, v78
    v_max_f32 v18, v18, v79
    v_mul_f32 v18, s90, v18
    v_pk_fma_f32 v[64:65], v[64:65], s[90:91], v[18:19] op_sel_hi:[1,1,0] neg_lo:[0,0,1] neg_hi:[0,0,1]
    v_pk_fma_f32 v[66:67], v[66:67], s[90:91], v[18:19] op_sel_hi:[1,1,0] neg_lo:[0,0,1] neg_hi:[0,0,1]
    v_pk_fma_f32 v[68:69], v[68:69], s[90:91], v[18:19] op_sel_hi:[1,1,0] neg_lo:[0,0,1] neg_hi:[0,0,1]
    v_pk_fma_f32 v[70:71], v[70:71], s[90:91], v[18:19] op_sel_hi:[1,1,0] neg_lo:[0,0,1] neg_hi:[0,0,1]
    v_pk_fma_f32 v[72:73], v[72:73], s[90:91], v[18:19] op_sel_hi:[1,1,0] neg_lo:[0,0,1] neg_hi:[0,0,1]
    v_pk_fma_f32 v[74:75], v[74:75], s[90:91], v[18:19] op_sel_hi:[1,1,0] neg_lo:[0,0,1] neg_hi:[0,0,1]
    v_pk_fma_f32 v[76:77], v[76:77], s[90:91], v[18:19] op_sel_hi:[1,1,0] neg_lo:[0,0,1] neg_hi:[0,0,1]
    v_pk_fma_f32 v[78:79], v[78:79], s[90:91], v[18:19] op_sel_hi:[1,1,0] neg_lo:[0,0,1] neg_hi:[0,0,1]
    v_exp_f32 v64, v64
    v_exp_f32 v65, v65
    v_exp_f32 v66, v66
    v_exp_f32 v67, v67
    v_exp_f32 v68, v68
    v_exp_f32 v69, v69
    v_exp_f32 v70, v70
    v_exp_f32 v71, v71
    v_exp_f32 v72, v72
    v_exp_f32 v73, v73
    v_exp_f32 v74, v74
    v_exp_f32 v75, v75
    v_exp_f32 v76, v76
    v_exp_f32 v77, v77
    v_exp_f32 v78, v78
    v_exp_f32 v79, v79
    v_pk_add_f32 v[18:19], v[64:65], v[66:67]
    v_pk_add_f32 v[18:19], v[18:19], v[68:69]
    v_pk_add_f32 v[18:19], v[18:19], v[70:71]
    v_pk_add_f32 v[18:19], v[18:19], v[72:73]
    v_pk_add_f32 v[18:19], v[18:19], v[74:75]
    v_pk_add_f32 v[18:19], v[18:19], v[76:77]
    v_pk_add_f32 v[18:19], v[18:19], v[78:79]
    v_add_f32 v18, v18, v19
    v_rcp_f32 v18, v18
    s_nop 0
    s_nop 0
    v_pk_mul_f32 v[64:65], v[18:19], v[64:65] op_sel:[0,0] op_sel_hi:[0,1]
    v_pk_mul_f32 v[66:67], v[18:19], v[66:67] op_sel:[0,0] op_sel_hi:[0,1]
    v_pk_mul_f32 v[68:69], v[18:19], v[68:69] op_sel:[0,0] op_sel_hi:[0,1]
    v_pk_mul_f32 v[70:71], v[18:19], v[70:71] op_sel:[0,0] op_sel_hi:[0,1]
    v_pk_mul_f32 v[72:73], v[18:19], v[72:73] op_sel:[0,0] op_sel_hi:[0,1]
    v_pk_mul_f32 v[74:75], v[18:19], v[74:75] op_sel:[0,0] op_sel_hi:[0,1]
    v_pk_mul_f32 v[76:77], v[18:19], v[76:77] op_sel:[0,0] op_sel_hi:[0,1]
    v_pk_mul_f32 v[78:79], v[18:19], v[78:79] op_sel:[0,0] op_sel_hi:[0,1]
    v_cvt_pk_bf16_f32 v10, v64, v65
    v_cvt_pk_bf16_f32 v11, v66, v67
    v_cvt_pk_bf16_f32 v12, v68, v69
    v_cvt_pk_bf16_f32 v13, v70, v71
    v_cvt_pk_bf16_f32 v14, v72, v73
    v_cvt_pk_bf16_f32 v15, v74, v75
    v_cvt_pk_bf16_f32 v16, v76, v77
    v_cvt_pk_bf16_f32 v17, v78, v79
    v_max3_f32 v18, v80, v81, v82
    v_max3_f32 v18, v18, v83, v84
    v_max3_f32 v18, v18, v85, v86
    v_max3_f32 v18, v18, v87, v88
    v_max3_f32 v18, v18, v89, v90
    v_max3_f32 v18, v18, v91, v92
    v_max3_f32 v18, v18, v93, v94
    v_max_f32 v18, v18, v95
    v_mul_f32 v18, s90, v18
    v_pk_fma_f32 v[80:81], v[80:81], s[90:91], v[18:19] op_sel_hi:[1,1,0] neg_lo:[0,0,1] neg_hi:[0,0,1]
    v_pk_fma_f32 v[82:83], v[82:83], s[90:91], v[18:19] op_sel_hi:[1,1,0] neg_lo:[0,0,1] neg_hi:[0,0,1]
    v_pk_fma_f32 v[84:85], v[84:85], s[90:91], v[18:19] op_sel_hi:[1,1,0] neg_lo:[0,0,1] neg_hi:[0,0,1]
    v_pk_fma_f32 v[86:87], v[86:87], s[90:91], v[18:19] op_sel_hi:[1,1,0] neg_lo:[0,0,1] neg_hi:[0,0,1]
    v_pk_fma_f32 v[88:89], v[88:89], s[90:91], v[18:19] op_sel_hi:[1,1,0] neg_lo:[0,0,1] neg_hi:[0,0,1]
    v_pk_fma_f32 v[90:91], v[90:91], s[90:91], v[18:19] op_sel_hi:[1,1,0] neg_lo:[0,0,1] neg_hi:[0,0,1]
    v_pk_fma_f32 v[92:93], v[92:93], s[90:91], v[18:19] op_sel_hi:[1,1,0] neg_lo:[0,0,1] neg_hi:[0,0,1]
    v_pk_fma_f32 v[94:95], v[94:95], s[90:91], v[18:19] op_sel_hi:[1,1,0] neg_lo:[0,0,1] neg_hi:[0,0,1]
    v_mfma_f32_32x32x16_bf16 v[96:111], v[10:13], v[42:45], 0
    v_exp_f32 v80, v80
    v_exp_f32 v81, v81
    v_exp_f32 v82, v82
    v_exp_f32 v83, v83
    v_exp_f32 v84, v84
    v_exp_f32 v85, v85
    v_mfma_f32_32x32x16_bf16 v[96:111], v[14:17], v[46:49], v[96:111]
    v_exp_f32 v86, v86
    v_exp_f32 v87, v87
    v_exp_f32 v88, v88
    v_exp_f32 v89, v89
    v_exp_f32 v90, v90
    v_exp_f32 v91, v91
    v_exp_f32 v92, v92
    v_exp_f32 v93, v93
    v_exp_f32 v94, v94
    v_exp_f32 v95, v95
    v_pk_add_f32 v[18:19], v[80:81], v[82:83]
    v_pk_add_f32 v[18:19], v[18:19], v[84:85]
    v_pk_add_f32 v[18:19], v[18:19], v[86:87]
    v_pk_add_f32 v[18:19], v[18:19], v[88:89]
    v_pk_add_f32 v[18:19], v[18:19], v[90:91]
    v_pk_add_f32 v[18:19], v[18:19], v[92:93]
    v_pk_add_f32 v[18:19], v[18:19], v[94:95]
    v_add_f32 v18, v18, v19
    v_rcp_f32 v18, v18
    s_nop 0
    s_nop 0
    v_pk_mul_f32 v[80:81], v[18:19], v[80:81] op_sel:[0,0] op_sel_hi:[0,1]
    v_pk_mul_f32 v[82:83], v[18:19], v[82:83] op_sel:[0,0] op_sel_hi:[0,1]
    v_pk_mul_f32 v[84:85], v[18:19], v[84:85] op_sel:[0,0] op_sel_hi:[0,1]
    v_pk_mul_f32 v[86:87], v[18:19], v[86:87] op_sel:[0,0] op_sel_hi:[0,1]
    v_pk_mul_f32 v[88:89], v[18:19], v[88:89] op_sel:[0,0] op_sel_hi:[0,1]
    v_pk_mul_f32 v[90:91], v[18:19], v[90:91] op_sel:[0,0] op_sel_hi:[0,1]
    v_pk_mul_f32 v[92:93], v[18:19], v[92:93] op_sel:[0,0] op_sel_hi:[0,1]
    v_pk_mul_f32 v[94:95], v[18:19], v[94:95] op_sel:[0,0] op_sel_hi:[0,1]
    v_cvt_pk_bf16_f32 v128, v96, v97
    v_cvt_pk_bf16_f32 v129, v98, v99
    v_cvt_pk_bf16_f32 v130, v100, v101
    v_cvt_pk_bf16_f32 v131, v102, v103
    v_cvt_pk_bf16_f32 v132, v104, v105
    v_cvt_pk_bf16_f32 v133, v106, v107
    v_cvt_pk_bf16_f32 v134, v108, v109
    v_cvt_pk_bf16_f32 v135, v110, v111
    v_cvt_pk_bf16_f32 v192, v80, v81
    v_cvt_pk_bf16_f32 v193, v82, v83
    v_cvt_pk_bf16_f32 v194, v84, v85
    v_cvt_pk_bf16_f32 v195, v86, v87
    v_cvt_pk_bf16_f32 v196, v88, v89
    v_cvt_pk_bf16_f32 v197, v90, v91
    v_cvt_pk_bf16_f32 v198, v92, v93
    v_cvt_pk_bf16_f32 v199, v94, v95
    v_max3_f32 v18, v160, v161, v162
    v_max3_f32 v18, v18, v163, v164
    v_max3_f32 v18, v18, v165, v166
    v_max3_f32 v18, v18, v167, v168
    v_max3_f32 v18, v18, v169, v170
    v_max3_f32 v18, v18, v171, v172
    v_max3_f32 v18, v18, v173, v174
    v_max_f32 v18, v18, v175
    v_mul_f32 v18, s90, v18
    v_pk_fma_f32 v[160:161], v[160:161], s[90:91], v[18:19] op_sel_hi:[1,1,0] neg_lo:[0,0,1] neg_hi:[0,0,1]
    v_pk_fma_f32 v[162:163], v[162:163], s[90:91], v[18:19] op_sel_hi:[1,1,0] neg_lo:[0,0,1] neg_hi:[0,0,1]
    v_pk_fma_f32 v[164:165], v[164:165], s[90:91], v[18:19] op_sel_hi:[1,1,0] neg_lo:[0,0,1] neg_hi:[0,0,1]
    v_pk_fma_f32 v[166:167], v[166:167], s[90:91], v[18:19] op_sel_hi:[1,1,0] neg_lo:[0,0,1] neg_hi:[0,0,1]
    v_pk_fma_f32 v[168:169], v[168:169], s[90:91], v[18:19] op_sel_hi:[1,1,0] neg_lo:[0,0,1] neg_hi:[0,0,1]
    v_pk_fma_f32 v[170:171], v[170:171], s[90:91], v[18:19] op_sel_hi:[1,1,0] neg_lo:[0,0,1] neg_hi:[0,0,1]
    v_pk_fma_f32 v[172:173], v[172:173], s[90:91], v[18:19] op_sel_hi:[1,1,0] neg_lo:[0,0,1] neg_hi:[0,0,1]
    v_pk_fma_f32 v[174:175], v[174:175], s[90:91], v[18:19] op_sel_hi:[1,1,0] neg_lo:[0,0,1] neg_hi:[0,0,1]
    v_mfma_f32_32x32x16_bf16 v[64:79], v[128:131], v[144:147], 0
    v_exp_f32 v160, v160
    v_exp_f32 v161, v161
    v_exp_f32_e64 v162, v162
    v_mfma_f32_32x32x16_bf16 v[64:79], v[132:135], v[148:151], v[64:79]
    v_exp_f32 v163, v163
    v_exp_f32 v164, v164
    v_exp_f32_e64 v165, v165
    v_mfma_f32_32x32x16_bf16 v[112:127], v[192:195], v[42:45], 0
    v_exp_f32 v166, v166
    v_exp_f32 v167, v167
    v_exp_f32_e64 v168, v168
    v_mfma_f32_32x32x16_bf16 v[112:127], v[196:199], v[46:49], v[112:127]
    v_exp_f32 v169, v169
    v_exp_f32 v170, v170
    v_exp_f32 v171, v171
    v_exp_f32 v172, v172
    v_exp_f32 v173, v173
    v_exp_f32 v174, v174
    v_exp_f32_e64 v175, v175
    v_pk_add_f32 v[18:19], v[160:161], v[162:163]
    v_pk_add_f32 v[18:19], v[18:19], v[164:165]
    v_pk_add_f32 v[18:19], v[18:19], v[166:167]
    v_pk_add_f32 v[18:19], v[18:19], v[168:169]
    v_pk_add_f32 v[18:19], v[18:19], v[170:171]
    v_pk_add_f32 v[18:19], v[18:19], v[172:173]
    v_pk_add_f32 v[18:19], v[18:19], v[174:175]
    v_add_f32 v18, v18, v19
    v_rcp_f32 v18, v18
    s_nop 0
    s_nop 0
    v_pk_mul_f32 v[160:161], v[18:19], v[160:161] op_sel:[0,0] op_sel_hi:[0,1]
    v_pk_mul_f32 v[162:163], v[18:19], v[162:163] op_sel:[0,0] op_sel_hi:[0,1]
    v_pk_mul_f32 v[164:165], v[18:19], v[164:165] op_sel:[0,0] op_sel_hi:[0,1]
    v_pk_mul_f32 v[166:167], v[18:19], v[166:167] op_sel:[0,0] op_sel_hi:[0,1]
    v_pk_mul_f32 v[168:169], v[18:19], v[168:169] op_sel:[0,0] op_sel_hi:[0,1]
    v_pk_mul_f32 v[170:171], v[18:19], v[170:171] op_sel:[0,0] op_sel_hi:[0,1]
    v_pk_mul_f32 v[172:173], v[18:19], v[172:173] op_sel:[0,0] op_sel_hi:[0,1]
    v_pk_mul_f32 v[174:175], v[18:19], v[174:175] op_sel:[0,0] op_sel_hi:[0,1]
    v_cvt_pk_bf16_f32 v136, v112, v113
    v_cvt_pk_bf16_f32 v137, v114, v115
    v_cvt_pk_bf16_f32 v138, v116, v117
    v_cvt_pk_bf16_f32 v139, v118, v119
    v_cvt_pk_bf16_f32 v140, v120, v121
    v_cvt_pk_bf16_f32 v141, v122, v123
    v_cvt_pk_bf16_f32 v142, v124, v125
    v_cvt_pk_bf16_f32 v143, v126, v127
    v_cvt_pk_bf16_f32 v10, v160, v161
    v_cvt_pk_bf16_f32 v11, v162, v163
    v_cvt_pk_bf16_f32 v12, v164, v165
    v_cvt_pk_bf16_f32 v13, v166, v167
    v_cvt_pk_bf16_f32 v14, v168, v169
    v_cvt_pk_bf16_f32 v15, v170, v171
    v_cvt_pk_bf16_f32 v16, v172, v173
    v_cvt_pk_bf16_f32 v17, v174, v175
    v_max3_f32 v18, v176, v177, v178
    v_max3_f32 v18, v18, v179, v180
    v_max3_f32 v18, v18, v181, v182
    v_max3_f32 v18, v18, v183, v184
    v_max3_f32 v18, v18, v185, v186
    v_max3_f32 v18, v18, v187, v188
    v_max3_f32 v18, v18, v189, v190
    v_max_f32 v18, v18, v191
    v_mul_f32 v18, s90, v18
    v_pk_fma_f32 v[176:177], v[176:177], s[90:91], v[18:19] op_sel_hi:[1,1,0] neg_lo:[0,0,1] neg_hi:[0,0,1]
    v_pk_fma_f32 v[178:179], v[178:179], s[90:91], v[18:19] op_sel_hi:[1,1,0] neg_lo:[0,0,1] neg_hi:[0,0,1]
    v_pk_fma_f32 v[180:181], v[180:181], s[90:91], v[18:19] op_sel_hi:[1,1,0] neg_lo:[0,0,1] neg_hi:[0,0,1]
    v_pk_fma_f32 v[182:183], v[182:183], s[90:91], v[18:19] op_sel_hi:[1,1,0] neg_lo:[0,0,1] neg_hi:[0,0,1]
    v_pk_fma_f32 v[184:185], v[184:185], s[90:91], v[18:19] op_sel_hi:[1,1,0] neg_lo:[0,0,1] neg_hi:[0,0,1]
    v_pk_fma_f32 v[186:187], v[186:187], s[90:91], v[18:19] op_sel_hi:[1,1,0] neg_lo:[0,0,1] neg_hi:[0,0,1]
    v_pk_fma_f32 v[188:189], v[188:189], s[90:91], v[18:19] op_sel_hi:[1,1,0] neg_lo:[0,0,1] neg_hi:[0,0,1]
    v_pk_fma_f32 v[190:191], v[190:191], s[90:91], v[18:19] op_sel_hi:[1,1,0] neg_lo:[0,0,1] neg_hi:[0,0,1]
    v_mfma_f32_32x32x16_bf16 v[64:79], v[136:139], v[152:155], v[64:79]
    v_exp_f32 v176, v176
    v_exp_f32 v177, v177
    v_exp_f32_e64 v178, v178
    v_mfma_f32_32x32x16_bf16 v[64:79], v[140:143], v[156:159], v[64:79]
    v_exp_f32 v179, v179
    v_exp_f32 v180, v180
    v_exp_f32_e64 v181, v181
    v_mfma_f32_32x32x16_bf16 v[96:111], v[10:13], v[42:45], 0
    v_exp_f32 v182, v182
    v_exp_f32 v183, v183
    v_exp_f32_e64 v184, v184
    v_mfma_f32_32x32x16_bf16 v[96:111], v[14:17], v[46:49], v[96:111]
    v_exp_f32 v185, v185
    v_exp_f32 v186, v186
    v_exp_f32 v187, v187
    v_exp_f32 v188, v188
    v_exp_f32 v189, v189
    v_exp_f32 v190, v190
    v_exp_f32_e64 v191, v191
    v_pk_add_f32 v[18:19], v[176:177], v[178:179]
    ds_write_b128 v40, v[64:67] offset:0
    v_pk_add_f32 v[18:19], v[18:19], v[180:181]
    v_pk_add_f32 v[18:19], v[18:19], v[182:183]
    v_pk_add_f32 v[18:19], v[18:19], v[184:185]
    v_pk_add_f32 v[18:19], v[18:19], v[186:187]
    ds_write_b128 v40, v[68:71] offset:1024
    v_pk_add_f32 v[18:19], v[18:19], v[188:189]
    v_pk_add_f32 v[18:19], v[18:19], v[190:191]
    v_add_f32 v18, v18, v19
    v_rcp_f32 v18, v18
    ds_write_b128 v40, v[72:75] offset:2048
    v_pk_mul_f32 v[176:177], v[18:19], v[176:177] op_sel:[0,0] op_sel_hi:[0,1]
    v_pk_mul_f32 v[178:179], v[18:19], v[178:179] op_sel:[0,0] op_sel_hi:[0,1]
    v_pk_mul_f32 v[180:181], v[18:19], v[180:181] op_sel:[0,0] op_sel_hi:[0,1]
    v_pk_mul_f32 v[182:183], v[18:19], v[182:183] op_sel:[0,0] op_sel_hi:[0,1]
    ds_write_b128 v40, v[76:79] offset:3072
    v_pk_mul_f32 v[184:185], v[18:19], v[184:185] op_sel:[0,0] op_sel_hi:[0,1]
    v_pk_mul_f32 v[186:187], v[18:19], v[186:187] op_sel:[0,0] op_sel_hi:[0,1]
    v_pk_mul_f32 v[188:189], v[18:19], v[188:189] op_sel:[0,0] op_sel_hi:[0,1]
    v_pk_mul_f32 v[190:191], v[18:19], v[190:191] op_sel:[0,0] op_sel_hi:[0,1]
    v_cvt_pk_bf16_f32 v192, v176, v177
    v_cvt_pk_bf16_f32 v193, v178, v179
    v_cvt_pk_bf16_f32 v194, v180, v181
    v_cvt_pk_bf16_f32 v195, v182, v183
    v_cvt_pk_bf16_f32 v196, v184, v185
    v_cvt_pk_bf16_f32 v197, v186, v187
    v_cvt_pk_bf16_f32 v198, v188, v189
    v_cvt_pk_bf16_f32 v199, v190, v191
    s_mov_b64 exec, 1
    ds_write_b32 v22, v9 offset:64
    s_mov_b64 exec, -1
    v_mfma_f32_32x32x16_bf16 v[112:127], v[192:195], v[42:45], 0
    v_cvt_pk_bf16_f32 v128, v96, v97
    v_cvt_pk_bf16_f32 v129, v98, v99
    v_mfma_f32_32x32x16_bf16 v[112:127], v[196:199], v[46:49], v[112:127]
    v_cvt_pk_bf16_f32 v130, v100, v101
    v_cvt_pk_bf16_f32 v131, v102, v103
    v_cvt_pk_bf16_f32 v132, v104, v105
    v_cvt_pk_bf16_f32 v133, v106, v107
    v_cvt_pk_bf16_f32 v134, v108, v109
    v_cvt_pk_bf16_f32 v135, v110, v111
    v_mfma_f32_32x32x16_bf16 v[80:95], v[128:131], v[200:203], 0
    s_nop 0
    v_mfma_f32_32x32x16_bf16 v[80:95], v[132:135], v[204:207], v[80:95]
L_MKV_kr:
    ds_read_b32 v2, v50 offset:64
    ds_read_b128 v[160:163], v41 offset:0
    ds_read_b128 v[164:167], v41 offset:1024
    ds_read_b128 v[168:171], v41 offset:2048
    ds_read_b128 v[172:175], v41 offset:3072
    s_waitcnt lgkmcnt(4)
    v_cmp_eq_u32 vcc, 0, v2
    s_cbranch_vccnz L_MKV_kr_r
L_MKV_kr_d:
    v_cvt_pk_bf16_f32 v136, v112, v113
    v_cvt_pk_bf16_f32 v137, v114, v115
    v_cvt_pk_bf16_f32 v138, v116, v117
    v_cvt_pk_bf16_f32 v139, v118, v119
    v_cvt_pk_bf16_f32 v140, v120, v121
    v_cvt_pk_bf16_f32 v141, v122, v123
    v_cvt_pk_bf16_f32 v142, v124, v125
    v_cvt_pk_bf16_f32 v143, v126, v127
    v_mfma_f32_32x32x16_bf16 v[80:95], v[136:139], v[208:211], v[80:95]
    s_nop 0
    v_mfma_f32_32x32x16_bf16 v[80:95], v[140:143], v[212:215], v[80:95]
    s_mov_b64 exec, 1
    ds_write_b32 v22, v9 offset:80
    s_mov_b64 exec, -1
    s_waitcnt lgkmcnt(1)
    s_nop 7
    v_add_f32 v80, v80, v160
    v_add_f32 v81, v81, v161
    v_add_f32 v82, v82, v162
    v_add_f32 v83, v83, v163
    v_add_f32 v84, v84, v164
    v_add_f32 v85, v85, v165
    v_add_f32 v86, v86, v166
    v_add_f32 v87, v87, v167
    v_add_f32 v88, v88, v168
    v_add_f32 v89, v89, v169
    v_add_f32 v90, v90, v170
    v_add_f32 v91, v91, v171
    v_add_f32 v92, v92, v172
    v_add_f32 v93, v93, v173
    v_add_f32 v94, v94, v174
    v_add_f32_e64 v95, v95, v175
    v_cvt_pk_bf16_f32 v10, v80, v81
    v_cvt_pk_bf16_f32 v11, v82, v83
    v_cvt_pk_bf16_f32 v12, v84, v85
    v_cvt_pk_bf16_f32 v13, v86, v87
    v_cvt_pk_bf16_f32 v14, v88, v89
    v_cvt_pk_bf16_f32 v15, v90, v91
    v_cvt_pk_bf16_f32 v16, v92, v93
    v_cvt_pk_bf16_f32 v17, v94, v95
    v_and_or_b32 v10, v10, -2, s30
    v_and_or_b32 v11, v11, -2, s31
    v_and_or_b32 v12, v12, -2, s30
    v_and_or_b32 v13, v13, -2, s31
    v_and_or_b32 v14, v14, -2, s30
    v_and_or_b32 v15, v15, -2, s31
    v_and_or_b32 v16, v16, -2, s30
    v_and_or_b32 v17, v17, -2, s31
    s_mov_b32 exec_lo, 0x3ffff
    s_mov_b32 exec_hi, 0x3ffff
    buffer_store_dwordx4 v[10:13], v38, s[64:67], s84 offen sc1
    buffer_store_dwordx4 v[14:17], v39, s[64:67], s84 offen sc1
    s_mov_b64 exec, -1
    s_setprio 0
    v_and_b32 v2, 16, v0
    v_lshrrev_b32 v2, 1, v2
    v_add_u32 v2, v2, v8
    s_lshl_b32 s85, s80, 5
    s_add_u32 s85, s85, s76
    s_lshl_b32 s85, s85, 1
    s_add_u32 s85, s85, 32
    v_add_u32 v2, s85, v2
    v_lshlrev_b32 v28, 6, v2
    v_and_b32 v3, 15, v0
    s_lshl_b32 s85, s81, 7
    v_lshl_add_u32 v3, v3, 3, s85
    v_lshl_add_u32 v2, v2, 10, v3
    v_add_u32 v4, 16384, v2
    v_lshlrev_b32 v25, 1, v2
    global_load_dwordx2 v[18:19], v2, s[4:5]
    global_load_dwordx2 v[20:21], v4, s[4:5]
    global_load_dwordx2 v[26:27], v3, s[20:21]
    s_mov_b32 s79, 0x6a0000
    buffer_load_dword v34, v28, s[64:67], s79 offen offset:0 sc1
    buffer_load_dword v35, v28, s[64:67], s79 offen offset:1024 sc1
    s_mul_i32 s38, s80, 196608
    s_mul_i32 s85, s76, 24576
    s_add_u32 s38, s38, s85
    v_and_b32 v4, 16, v0
    v_mul_u32_u24 v3, 12288, v8
    v_lshl_add_u32 v3, v4, 7, v3
    v_and_b32 v33, 0x70, v6
    v_add_u32_e64 v33, v33, v3
    v_add_u32 v33, 104320, v33
    v_add_u32 v40, 98304, v6
    s_waitcnt vmcnt(0)
L_MKV_g:
    v_bitop3_b32 v2, v34, v35, v51 bitop3:0x7e
    v_and_b32 v2, 0xff, v2
    v_cmp_ne_u32 vcc, 0, v2
    s_cbranch_vccnz L_MKV_g_r
L_MKV_g_d:
    v_lshlrev_b32 v2, 16, v26
    v_and_b32 v3, 0xffff0000, v26
    v_lshlrev_b32_e64 v4, 16, v27
    v_and_b32 v5, 0xffff0000, v27
    v_lshlrev_b32_e64 v42, 16, v18
    v_and_b32 v43, 0xffff0000, v18
    v_mul_f32 v42, v42, v2
    v_mul_f32 v43, v43, v3
    v_lshlrev_b32_e64 v44, 16, v19
    v_and_b32 v45, 0xffff0000, v19
    v_mul_f32 v44, v44, v4
    v_mul_f32 v45, v45, v5
    v_lshlrev_b32_e64 v46, 16, v20
    v_and_b32 v47, 0xffff0000, v20
    v_mul_f32 v46, v46, v2
    v_mul_f32 v47, v47, v3
    v_lshlrev_b32_e64 v48, 16, v21
    v_and_b32 v49, 0xffff0000, v21
    v_mul_f32 v48, v48, v4
    v_mul_f32 v49, v49, v5
    v_and_b32 v4, 7, v0
    v_xor_b32 v4, v4, v8
    v_lshlrev_b32_e64 v4, 4, v4
    v_lshl_add_u32 v4, v7, 8, v4
    v_add_u32 v18, s39, v4
    v_xor_b32 v19, 32, v18
    v_xor_b32_e64 v20, 64, v18
    v_xor_b32 v21, 96, v18
    v_lshrrev_b32 v4, 4, v0
    v_xor_b32 v4, v4, v0
    s_lshl_b32 s85, s76, 11
    v_lshl_add_u32 v4, v4, 4, s85
    v_add_u32 v56, 16384, v4
    v_xor_b32 v57, 64, v56
    v_add_u32 v58, 106496, v4
    v_xor_b32 v59, 64, v58
    s_mov_b64 s[68:69], s[32:33]
    s_mov_b32 s70, 0x400000
    s_mov_b32 s71, 0x20000
    s_lshl_b32 s85, s87, 15
    s_sub_u32 s85, 98304, s85
    v_add_u32 v10, s85, v29
    v_add_u32 v11, s85, v30
    v_add_u32 v12, s85, v31
    v_add_u32_e64 v13, s85, v32
L_MKV_cw:
    ds_read_b32 v2, v22 offset:96
    s_waitcnt lgkmcnt(0)
    v_cmp_eq_u32 vcc, 0, v2
    s_cbranch_vccnz L_MKV_cw_r
L_MKV_cw_d:
    buffer_load_dwordx4 v[36:39], v33, s[64:67], s38 offen sc1
    s_waitcnt vmcnt(0)
L_MKV_hp:
    v_bitop3_b32 v2, v36, v37, s30 bitop3:0xdb
    v_bitop3_b32 v3, v38, v39, s30 bitop3:0xdb
    v_or_b32 v2, v2, v3
    v_and_b32 v2, 1, v2
    v_cmp_ne_u32 vcc, 0, v2
    s_cbranch_vccnz L_MKV_hp_r
L_MKV_hp_d:
L_MKV_g2:
    s_add_u32 s23, s38, 0
    buffer_load_dwordx4 v[14:17], v6, s[64:67], s23 offen offset:0 sc1
    buffer_load_dwordx4 v[124:127], v40, s[64:67], s23 offen offset:0 sc1
    buffer_load_dwordx4 v[128:131], v6, s[64:67], s23 offen offset:1024 sc1
    buffer_load_dwordx4 v[132:135], v40, s[64:67], s23 offen offset:1024 sc1
    buffer_load_dwordx4 v[136:139], v6, s[64:67], s23 offen offset:2048 sc1
    buffer_load_dwordx4 v[140:143], v40, s[64:67], s23 offen offset:2048 sc1
    buffer_load_dwordx4 v[144:147], v6, s[64:67], s23 offen offset:3072 sc1
    buffer_load_dwordx4 v[148:151], v40, s[64:67], s23 offen offset:3072 sc1
    s_add_u32 s23, s38, 4096
    buffer_load_dwordx4 v[152:155], v6, s[64:67], s23 offen offset:0 sc1
    buffer_load_dwordx4 v[156:159], v40, s[64:67], s23 offen offset:0 sc1
    buffer_load_dwordx4 v[160:163], v6, s[64:67], s23 offen offset:1024 sc1
    buffer_load_dwordx4 v[164:167], v40, s[64:67], s23 offen offset:1024 sc1
    ds_read_b128 v[200:203], v29 offset:16384
    ds_read_b128 v[204:207], v29 offset:20480
    ds_read_b128 v[208:211], v30 offset:16384
    ds_read_b128 v[212:215], v30 offset:20480
    ds_read_b128 v[216:219], v31 offset:16384
    ds_read_b128 v[220:223], v31 offset:20480
    buffer_load_dwordx4 v[168:171], v6, s[64:67], s23 offen offset:2048 sc1
    ds_read_b128 v[224:227], v32 offset:16384
    ds_read_b128 v[228:231], v32 offset:20480
    s_waitcnt lgkmcnt(6)
    s_waitcnt vmcnt(12)
    v_mfma_f32_32x32x16_bf16 v[60:75], v[200:203], v[14:17], 0
    v_bitop3_b32 v2, v14, v15, s30 bitop3:0xdb
    v_bitop3_b32 v3, v16, v17, s30 bitop3:0xdb
    v_or_b32 v41, v2, v3
    v_mfma_f32_32x32x16_bf16 v[92:107], v[204:207], v[14:17], 0
    buffer_load_dwordx4 v[172:175], v40, s[64:67], s23 offen offset:2048 sc1
    s_waitcnt vmcnt(12)
    v_mfma_f32_32x32x16_bf16 v[76:91], v[200:203], v[124:127], 0
    v_bitop3_b32 v2, v124, v125, s30 bitop3:0xdb
    v_bitop3_b32 v3, v126, v127, s30 bitop3:0xdb
    v_or3_b32 v41, v41, v2, v3
    v_mfma_f32_32x32x16_bf16 v[108:123], v[204:207], v[124:127], 0
    buffer_load_dwordx4 v[176:179], v6, s[64:67], s23 offen offset:3072 sc1
    ds_read_b128 v[200:203], v29 offset:32768
    ds_read_b128 v[204:207], v29 offset:36864
    s_waitcnt lgkmcnt(6)
    s_waitcnt vmcnt(12)
    v_mfma_f32_32x32x16_bf16 v[60:75], v[208:211], v[128:131], v[60:75]
    v_bitop3_b32 v2, v128, v129, s30 bitop3:0xdb
    v_bitop3_b32 v3, v130, v131, s30 bitop3:0xdb
    v_or3_b32 v41, v41, v2, v3
    v_mfma_f32_32x32x16_bf16 v[92:107], v[212:215], v[128:131], v[92:107]
    buffer_load_dwordx4 v[180:183], v40, s[64:67], s23 offen offset:3072 sc1
    s_waitcnt vmcnt(12)
    v_mfma_f32_32x32x16_bf16 v[76:91], v[208:211], v[132:135], v[76:91]
    v_bitop3_b32 v2, v132, v133, s30 bitop3:0xdb
    v_bitop3_b32 v3, v134, v135, s30 bitop3:0xdb
    v_or3_b32 v41, v41, v2, v3
    v_mfma_f32_32x32x16_bf16 v[108:123], v[212:215], v[132:135], v[108:123]
    s_add_u32 s23, s38, 12288
    buffer_load_dwordx4 v[184:187], v6, s[64:67], s23 offen offset:0 sc1
    ds_read_b128 v[208:211], v30 offset:32768
    ds_read_b128 v[212:215], v30 offset:36864
    s_waitcnt lgkmcnt(6)
    s_waitcnt vmcnt(12)
    v_mfma_f32_32x32x16_bf16 v[60:75], v[216:219], v[136:139], v[60:75]
    v_bitop3_b32 v2, v136, v137, s30 bitop3:0xdb
    v_bitop3_b32 v3, v138, v139, s30 bitop3:0xdb
    v_or3_b32 v41, v41, v2, v3
    v_mfma_f32_32x32x16_bf16 v[92:107], v[220:223], v[136:139], v[92:107]
    buffer_load_dwordx4 v[188:191], v40, s[64:67], s23 offen offset:0 sc1
    s_waitcnt vmcnt(12)
    v_mfma_f32_32x32x16_bf16 v[76:91], v[216:219], v[140:143], v[76:91]
    v_bitop3_b32 v2, v140, v141, s30 bitop3:0xdb
    v_bitop3_b32 v3, v142, v143, s30 bitop3:0xdb
    v_or3_b32 v41, v41, v2, v3
    v_mfma_f32_32x32x16_bf16 v[108:123], v[220:223], v[140:143], v[108:123]
    buffer_load_dwordx4 v[192:195], v6, s[64:67], s23 offen offset:1024 sc1
    ds_read_b128 v[216:219], v31 offset:32768
    ds_read_b128 v[220:223], v31 offset:36864
    s_waitcnt lgkmcnt(6)
    s_waitcnt vmcnt(12)
    v_mfma_f32_32x32x16_bf16 v[60:75], v[224:227], v[144:147], v[60:75]
    v_bitop3_b32 v2, v144, v145, s30 bitop3:0xdb
    v_bitop3_b32 v3, v146, v147, s30 bitop3:0xdb
    v_or3_b32 v41, v41, v2, v3
    v_mfma_f32_32x32x16_bf16 v[92:107], v[228:231], v[144:147], v[92:107]
    buffer_load_dwordx4 v[196:199], v40, s[64:67], s23 offen offset:1024 sc1
    s_waitcnt vmcnt(12)
    v_mfma_f32_32x32x16_bf16 v[76:91], v[224:227], v[148:151], v[76:91]
    v_bitop3_b32 v2, v148, v149, s30 bitop3:0xdb
    v_bitop3_b32 v3, v150, v151, s30 bitop3:0xdb
    v_or3_b32 v41, v41, v2, v3
    v_mfma_f32_32x32x16_bf16 v[108:123], v[228:231], v[148:151], v[108:123]
    buffer_load_dwordx4 v[14:17], v6, s[64:67], s23 offen offset:2048 sc1
    ds_read_b128 v[224:227], v32 offset:32768
    ds_read_b128 v[228:231], v32 offset:36864
    s_waitcnt lgkmcnt(6)
    s_waitcnt vmcnt(12)
    v_mfma_f32_32x32x16_bf16 v[60:75], v[200:203], v[152:155], v[60:75]
    v_bitop3_b32 v2, v152, v153, s30 bitop3:0xdb
    v_bitop3_b32 v3, v154, v155, s30 bitop3:0xdb
    v_or3_b32 v41, v41, v2, v3
    v_mfma_f32_32x32x16_bf16 v[92:107], v[204:207], v[152:155], v[92:107]
    buffer_load_dwordx4 v[124:127], v40, s[64:67], s23 offen offset:2048 sc1
    s_waitcnt vmcnt(12)
    v_mfma_f32_32x32x16_bf16 v[76:91], v[200:203], v[156:159], v[76:91]
    v_bitop3_b32 v2, v156, v157, s30 bitop3:0xdb
    v_bitop3_b32 v3, v158, v159, s30 bitop3:0xdb
    v_or3_b32 v41, v41, v2, v3
    v_mfma_f32_32x32x16_bf16 v[108:123], v[204:207], v[156:159], v[108:123]
    buffer_load_dwordx4 v[128:131], v6, s[64:67], s23 offen offset:3072 sc1
    ds_read_b128 v[200:203], v29 offset:0
    ds_read_b128 v[204:207], v29 offset:4096
    s_waitcnt lgkmcnt(6)
    s_waitcnt vmcnt(12)
    v_mfma_f32_32x32x16_bf16 v[60:75], v[208:211], v[160:163], v[60:75]
    v_bitop3_b32 v2, v160, v161, s30 bitop3:0xdb
    v_bitop3_b32 v3, v162, v163, s30 bitop3:0xdb
    v_or3_b32 v41, v41, v2, v3
    v_mfma_f32_32x32x16_bf16 v[92:107], v[212:215], v[160:163], v[92:107]
    buffer_load_dwordx4 v[132:135], v40, s[64:67], s23 offen offset:3072 sc1
    s_waitcnt vmcnt(12)
    v_mfma_f32_32x32x16_bf16 v[76:91], v[208:211], v[164:167], v[76:91]
    v_bitop3_b32 v2, v164, v165, s30 bitop3:0xdb
    v_bitop3_b32 v3, v166, v167, s30 bitop3:0xdb
    v_or3_b32 v41, v41, v2, v3
    v_mfma_f32_32x32x16_bf16 v[108:123], v[212:215], v[164:167], v[108:123]
    s_add_u32 s23, s38, 16384
    buffer_load_dwordx4 v[136:139], v6, s[64:67], s23 offen offset:0 sc1
    ds_read_b128 v[208:211], v30 offset:0
    ds_read_b128 v[212:215], v30 offset:4096
    s_waitcnt lgkmcnt(6)
    s_waitcnt vmcnt(12)
    v_mfma_f32_32x32x16_bf16 v[60:75], v[216:219], v[168:171], v[60:75]
    v_bitop3_b32 v2, v168, v169, s30 bitop3:0xdb
    v_bitop3_b32 v3, v170, v171, s30 bitop3:0xdb
    v_or3_b32 v41, v41, v2, v3
    v_mfma_f32_32x32x16_bf16 v[92:107], v[220:223], v[168:171], v[92:107]
    buffer_load_dwordx4 v[140:143], v40, s[64:67], s23 offen offset:0 sc1
    s_waitcnt vmcnt(12)
    v_mfma_f32_32x32x16_bf16 v[76:91], v[216:219], v[172:175], v[76:91]
    v_bitop3_b32 v2, v172, v173, s30 bitop3:0xdb
    v_bitop3_b32 v3, v174, v175, s30 bitop3:0xdb
    v_or3_b32 v41, v41, v2, v3
    v_mfma_f32_32x32x16_bf16 v[108:123], v[220:223], v[172:175], v[108:123]
    buffer_load_dwordx4 v[144:147], v6, s[64:67], s23 offen offset:1024 sc1
    ds_read_b128 v[216:219], v31 offset:0
    ds_read_b128 v[220:223], v31 offset:4096
    s_waitcnt lgkmcnt(6)
    s_waitcnt vmcnt(12)
    v_mfma_f32_32x32x16_bf16 v[60:75], v[224:227], v[176:179], v[60:75]
    v_bitop3_b32 v2, v176, v177, s30 bitop3:0xdb
    v_bitop3_b32 v3, v178, v179, s30 bitop3:0xdb
    v_or3_b32 v41, v41, v2, v3
    v_mfma_f32_32x32x16_bf16 v[92:107], v[228:231], v[176:179], v[92:107]
    buffer_load_dwordx4 v[148:151], v40, s[64:67], s23 offen offset:1024 sc1
    s_waitcnt vmcnt(12)
    v_mfma_f32_32x32x16_bf16 v[76:91], v[224:227], v[180:183], v[76:91]
    v_bitop3_b32 v2, v180, v181, s30 bitop3:0xdb
    v_bitop3_b32 v3, v182, v183, s30 bitop3:0xdb
    v_or3_b32 v41, v41, v2, v3
    v_mfma_f32_32x32x16_bf16 v[108:123], v[228:231], v[180:183], v[108:123]
    buffer_load_dwordx4 v[152:155], v6, s[64:67], s23 offen offset:2048 sc1
    ds_read_b128 v[224:227], v32 offset:0
    ds_read_b128 v[228:231], v32 offset:4096
    s_waitcnt lgkmcnt(6)
    s_waitcnt vmcnt(12)
    v_mfma_f32_32x32x16_bf16 v[60:75], v[200:203], v[184:187], v[60:75]
    v_bitop3_b32 v2, v184, v185, s30 bitop3:0xdb
    v_bitop3_b32 v3, v186, v187, s30 bitop3:0xdb
    v_or3_b32 v41, v41, v2, v3
    v_mfma_f32_32x32x16_bf16 v[92:107], v[204:207], v[184:187], v[92:107]
    buffer_load_dwordx4 v[156:159], v40, s[64:67], s23 offen offset:2048 sc1
    s_waitcnt vmcnt(12)
    v_mfma_f32_32x32x16_bf16 v[76:91], v[200:203], v[188:191], v[76:91]
    v_bitop3_b32 v2, v188, v189, s30 bitop3:0xdb
    v_bitop3_b32 v3, v190, v191, s30 bitop3:0xdb
    v_or3_b32 v41, v41, v2, v3
    v_mfma_f32_32x32x16_bf16 v[108:123], v[204:207], v[188:191], v[108:123]
    buffer_load_dwordx4 v[160:163], v6, s[64:67], s23 offen offset:3072 sc1
    ds_read_b128 v[200:203], v10 offset:0
    ds_read_b128 v[204:207], v10 offset:4096
    s_waitcnt lgkmcnt(6)
    s_waitcnt vmcnt(12)
    v_mfma_f32_32x32x16_bf16 v[60:75], v[208:211], v[192:195], v[60:75]
    v_bitop3_b32 v2, v192, v193, s30 bitop3:0xdb
    v_bitop3_b32 v3, v194, v195, s30 bitop3:0xdb
    v_or3_b32 v41, v41, v2, v3
    v_mfma_f32_32x32x16_bf16 v[92:107], v[212:215], v[192:195], v[92:107]
    buffer_load_dwordx4 v[164:167], v40, s[64:67], s23 offen offset:3072 sc1
    s_waitcnt vmcnt(12)
    v_mfma_f32_32x32x16_bf16 v[76:91], v[208:211], v[196:199], v[76:91]
    v_bitop3_b32 v2, v196, v197, s30 bitop3:0xdb
    v_bitop3_b32 v3, v198, v199, s30 bitop3:0xdb
    v_or3_b32 v41, v41, v2, v3
    v_mfma_f32_32x32x16_bf16 v[108:123], v[212:215], v[196:199], v[108:123]
    ds_read_b128 v[208:211], v11 offset:0
    ds_read_b128 v[212:215], v11 offset:4096
    s_waitcnt lgkmcnt(6)
    s_waitcnt vmcnt(11)
    v_mfma_f32_32x32x16_bf16 v[60:75], v[216:219], v[14:17], v[60:75]
    v_bitop3_b32 v2, v14, v15, s30 bitop3:0xdb
    v_bitop3_b32 v3, v16, v17, s30 bitop3:0xdb
    v_or3_b32 v41, v41, v2, v3
    v_mfma_f32_32x32x16_bf16 v[92:107], v[220:223], v[14:17], v[92:107]
    s_waitcnt vmcnt(10)
    v_mfma_f32_32x32x16_bf16 v[76:91], v[216:219], v[124:127], v[76:91]
    v_bitop3_b32 v2, v124, v125, s30 bitop3:0xdb
    v_bitop3_b32 v3, v126, v127, s30 bitop3:0xdb
    v_or3_b32 v41, v41, v2, v3
    v_mfma_f32_32x32x16_bf16 v[108:123], v[220:223], v[124:127], v[108:123]
    ds_read_b128 v[216:219], v12 offset:0
    ds_read_b128 v[220:223], v12 offset:4096
    s_waitcnt lgkmcnt(6)
    s_waitcnt vmcnt(9)
    v_mfma_f32_32x32x16_bf16 v[60:75], v[224:227], v[128:131], v[60:75]
    v_bitop3_b32 v2, v128, v129, s30 bitop3:0xdb
    v_bitop3_b32 v3, v130, v131, s30 bitop3:0xdb
    v_or3_b32 v41, v41, v2, v3
    v_mfma_f32_32x32x16_bf16 v[92:107], v[228:231], v[128:131], v[92:107]
    s_waitcnt vmcnt(8)
    v_mfma_f32_32x32x16_bf16 v[76:91], v[224:227], v[132:135], v[76:91]
    v_bitop3_b32 v2, v132, v133, s30 bitop3:0xdb
    v_bitop3_b32 v3, v134, v135, s30 bitop3:0xdb
    v_or3_b32 v41, v41, v2, v3
    v_mfma_f32_32x32x16_bf16 v[108:123], v[228:231], v[132:135], v[108:123]
    ds_read_b128 v[224:227], v13 offset:0
    ds_read_b128 v[228:231], v13 offset:4096
    s_waitcnt lgkmcnt(6)
    s_waitcnt vmcnt(7)
    v_mfma_f32_32x32x16_bf16 v[60:75], v[200:203], v[136:139], v[60:75]
    v_bitop3_b32 v2, v136, v137, s30 bitop3:0xdb
    v_bitop3_b32 v3, v138, v139, s30 bitop3:0xdb
    v_or3_b32 v41, v41, v2, v3
    v_mfma_f32_32x32x16_bf16 v[92:107], v[204:207], v[136:139], v[92:107]
    s_waitcnt vmcnt(6)
    v_mfma_f32_32x32x16_bf16 v[76:91], v[200:203], v[140:143], v[76:91]
    v_bitop3_b32 v2, v140, v141, s30 bitop3:0xdb
    v_bitop3_b32 v3, v142, v143, s30 bitop3:0xdb
    v_or3_b32 v41, v41, v2, v3
    v_mfma_f32_32x32x16_bf16 v[108:123], v[204:207], v[140:143], v[108:123]
    s_waitcnt lgkmcnt(4)
    s_waitcnt vmcnt(5)
    v_mfma_f32_32x32x16_bf16 v[60:75], v[208:211], v[144:147], v[60:75]
    v_bitop3_b32 v2, v144, v145, s30 bitop3:0xdb
    v_bitop3_b32 v3, v146, v147, s30 bitop3:0xdb
    v_or3_b32 v41, v41, v2, v3
    v_mfma_f32_32x32x16_bf16 v[92:107], v[212:215], v[144:147], v[92:107]
    s_waitcnt vmcnt(4)
    v_mfma_f32_32x32x16_bf16 v[76:91], v[208:211], v[148:151], v[76:91]
    v_bitop3_b32 v2, v148, v149, s30 bitop3:0xdb
    v_bitop3_b32 v3, v150, v151, s30 bitop3:0xdb
    v_or3_b32 v41, v41, v2, v3
    v_mfma_f32_32x32x16_bf16 v[108:123], v[212:215], v[148:151], v[108:123]
    s_waitcnt lgkmcnt(2)
    s_waitcnt vmcnt(3)
    v_mfma_f32_32x32x16_bf16 v[60:75], v[216:219], v[152:155], v[60:75]
    v_bitop3_b32 v2, v152, v153, s30 bitop3:0xdb
    v_bitop3_b32 v3, v154, v155, s30 bitop3:0xdb
    v_or3_b32 v41, v41, v2, v3
    v_mfma_f32_32x32x16_bf16 v[92:107], v[220:223], v[152:155], v[92:107]
    s_waitcnt vmcnt(2)
    v_mfma_f32_32x32x16_bf16 v[76:91], v[216:219], v[156:159], v[76:91]
    v_bitop3_b32 v2, v156, v157, s30 bitop3:0xdb
    v_bitop3_b32 v3, v158, v159, s30 bitop3:0xdb
    v_or3_b32 v41, v41, v2, v3
    v_mfma_f32_32x32x16_bf16 v[108:123], v[220:223], v[156:159], v[108:123]
    s_waitcnt lgkmcnt(0)
    s_waitcnt vmcnt(1)
    v_mfma_f32_32x32x16_bf16 v[60:75], v[224:227], v[160:163], v[60:75]
    v_bitop3_b32 v2, v160, v161, s30 bitop3:0xdb
    v_bitop3_b32 v3, v162, v163, s30 bitop3:0xdb
    v_or3_b32 v41, v41, v2, v3
    v_mfma_f32_32x32x16_bf16 v[92:107], v[228:231], v[160:163], v[92:107]
    s_waitcnt vmcnt(0)
    v_mfma_f32_32x32x16_bf16 v[76:91], v[224:227], v[164:167], v[76:91]
    v_bitop3_b32 v2, v164, v165, s30 bitop3:0xdb
    v_bitop3_b32 v3, v166, v167, s30 bitop3:0xdb
    v_or3_b32 v41, v41, v2, v3
    v_mfma_f32_32x32x16_bf16 v[108:123], v[228:231], v[164:167], v[108:123]
    v_and_b32 v41, 1, v41
    v_cmp_ne_u32 vcc, 0, v41
    s_cbranch_vccnz L_MKV_g2_r
L_MKV_g2_d:
    ds_write_b128 v18, v[60:63] offset:0
    ds_write_b128 v19, v[64:67] offset:0
    ds_write_b128 v20, v[68:71] offset:0
    ds_write_b128 v21, v[72:75] offset:0
    ds_write_b128 v18, v[92:95] offset:128
    ds_write_b128 v19, v[96:99] offset:128
    ds_write_b128 v20, v[100:103] offset:128
    ds_write_b128 v21, v[104:107] offset:128
    ds_write_b128 v18, v[76:79] offset:16384
    ds_write_b128 v19, v[80:83] offset:16384
    ds_write_b128 v20, v[84:87] offset:16384
    ds_write_b128 v21, v[88:91] offset:16384
    ds_write_b128 v18, v[108:111] offset:16512
    ds_write_b128 v19, v[112:115] offset:16512
    ds_write_b128 v20, v[116:119] offset:16512
    ds_write_b128 v21, v[120:123] offset:16512
    s_barrier
    s_waitcnt lgkmcnt(0)
    s_barrier
    ds_read_b128 v[14:17], v56 offset:0
    ds_read_b128 v[124:127], v56 offset:8192
    ds_read_b128 v[128:131], v56 offset:49152
    ds_read_b128 v[132:135], v56 offset:57344
    ds_read_b128 v[136:139], v58 offset:0
    ds_read_b128 v[140:143], v58 offset:16384
    ds_read_b128 v[144:147], v58 offset:32768
    ds_read_b128 v[148:151], v58 offset:49152
    ds_read_b128 v[152:155], v57 offset:1024
    ds_read_b128 v[156:159], v57 offset:9216
    ds_read_b128 v[160:163], v57 offset:50176
    ds_read_b128 v[164:167], v57 offset:58368
    ds_read_b128 v[168:171], v59 offset:1024
    ds_read_b128 v[172:175], v59 offset:17408
    ds_read_b128 v[176:179], v59 offset:33792
    ds_read_b128 v[180:183], v59 offset:50176
    s_mov_b32 s23, 32768
    s_waitcnt lgkmcnt(12)
    s_nop 0
    v_pk_add_f32 v[42:43], v[42:43], v[14:15]
    v_pk_add_f32 v[44:45], v[44:45], v[16:17]
    v_pk_add_f32 v[42:43], v[42:43], v[124:125]
    v_pk_add_f32 v[44:45], v[44:45], v[126:127]
    v_pk_add_f32 v[42:43], v[42:43], v[128:129]
    v_pk_add_f32 v[44:45], v[44:45], v[130:131]
    v_pk_add_f32 v[42:43], v[42:43], v[132:133]
    v_pk_add_f32 v[44:45], v[44:45], v[134:135]
    s_waitcnt lgkmcnt(8)
    s_nop 0
    v_pk_add_f32 v[136:137], v[136:137], v[140:141]
    v_pk_add_f32 v[138:139], v[138:139], v[142:143]
    v_pk_add_f32 v[136:137], v[136:137], v[144:145]
    v_pk_add_f32 v[138:139], v[138:139], v[146:147]
    v_pk_add_f32 v[136:137], v[136:137], v[148:149]
    v_pk_add_f32 v[138:139], v[138:139], v[150:151]
    v_pk_add_f32 v[42:43], v[42:43], v[136:137] neg_lo:[0,1] neg_hi:[0,1]
    v_pk_add_f32 v[44:45], v[44:45], v[138:139] neg_lo:[0,1] neg_hi:[0,1]
    v_pk_fma_f32 v[136:137], v[34:35], v[42:43], v[136:137] op_sel:[0,0,0] op_sel_hi:[0,1,1]
    v_pk_fma_f32 v[138:139], v[34:35], v[44:45], v[138:139] op_sel:[0,0,0] op_sel_hi:[0,1,1]
    buffer_store_dwordx4 v[136:139], v25, s[68:71], 0 offen sc1
    s_waitcnt lgkmcnt(4)
    s_nop 0
    v_pk_add_f32 v[46:47], v[46:47], v[152:153]
    v_pk_add_f32 v[48:49], v[48:49], v[154:155]
    v_pk_add_f32 v[46:47], v[46:47], v[156:157]
    v_pk_add_f32 v[48:49], v[48:49], v[158:159]
    v_pk_add_f32 v[46:47], v[46:47], v[160:161]
    v_pk_add_f32 v[48:49], v[48:49], v[162:163]
    v_pk_add_f32 v[46:47], v[46:47], v[164:165]
    v_pk_add_f32 v[48:49], v[48:49], v[166:167]
    s_waitcnt lgkmcnt(0)
    s_nop 0
    v_pk_add_f32 v[168:169], v[168:169], v[172:173]
    v_pk_add_f32 v[170:171], v[170:171], v[174:175]
    v_pk_add_f32 v[168:169], v[168:169], v[176:177]
    v_pk_add_f32 v[170:171], v[170:171], v[178:179]
    v_pk_add_f32 v[168:169], v[168:169], v[180:181]
    v_pk_add_f32 v[170:171], v[170:171], v[182:183]
    v_pk_add_f32 v[46:47], v[46:47], v[168:169] neg_lo:[0,1] neg_hi:[0,1]
    v_pk_add_f32 v[48:49], v[48:49], v[170:171] neg_lo:[0,1] neg_hi:[0,1]
    v_pk_fma_f32 v[168:169], v[34:35], v[46:47], v[168:169] op_sel:[1,0,0] op_sel_hi:[1,1,1]
    v_pk_fma_f32 v[170:171], v[34:35], v[48:49], v[170:171] op_sel:[1,0,0] op_sel_hi:[1,1,1]
    buffer_store_dwordx4 v[168:171], v25, s[68:71], s23 offen sc1
    s_endpgm
L_MKV_kr_r:
    s_waitcnt lgkmcnt(0)
    s_cmp_eq_u32 s88, 0
    s_cbranch_scc1 L_MKV_kr_d
    s_sub_u32 s88, s88, 1
    s_branch L_MKV_kr
L_MKV_g_r:
    s_cmp_eq_u32 s88, 0
    s_cbranch_scc1 L_MKV_g_d
    s_sub_u32 s88, s88, 1
    buffer_load_dword v34, v28, s[64:67], s79 offen offset:0 sc1
    buffer_load_dword v35, v28, s[64:67], s79 offen offset:1024 sc1
    s_waitcnt vmcnt(0)
    s_branch L_MKV_g
L_MKV_cw_r:
    s_waitcnt lgkmcnt(0)
    s_cmp_eq_u32 s88, 0
    s_cbranch_scc1 L_MKV_cw_d
    s_sub_u32 s88, s88, 1
    s_sleep 2
    s_branch L_MKV_cw
L_MKV_hp_r:
    s_cmp_eq_u32 s88, 0
    s_cbranch_scc1 L_MKV_hp_d
    s_sub_u32 s88, s88, 1
    buffer_load_dwordx4 v[36:39], v33, s[64:67], s38 offen sc1
    s_waitcnt vmcnt(0)
    s_branch L_MKV_hp
L_MKV_g2_r:
    s_cmp_eq_u32 s88, 0
    s_cbranch_scc1 L_MKV_g2_d
    s_sub_u32 s88, s88, 1
    s_nop 15
    s_waitcnt vmcnt(0) lgkmcnt(0)
    s_branch L_MKV_g2
.p2align 3
L_MS:
    s_setprio 1
    s_and_b32 s85, s2, 7
    s_bfe_u32 s3, s2, 0x20003
    s_lshl_b32 s85, s85, 2
    s_add_u32 s80, s85, s3
    s_lshr_b32 s81, s2, 5
    s_mov_b64 s[64:65], s[36:37]
    s_mov_b32 s66, 0x6f1000
    s_mov_b32 s67, 0x20000
    s_mov_b32 s90, 0x3fb8aa3b
    s_mov_b32 s91, 0x3fb8aa3b
    s_mov_b32 s88, 200000
    s_mov_b32 s34, 0xffff
    s_mov_b32 s35, 0xffff
    v_mov_b32 v9, 133120
    v_lshl_add_u32 v22, s76, 2, v9
    v_mov_b32_e64 v23, 0
    s_mul_i32 s39, s87, 49152
    s_lshl_b32 s85, s86, 13
    s_add_u32 s39, s39, s85
    s_lshl_b32 s85, s77, 1
    s_add_u32 s85, s85, s87
    s_mul_i32 s38, s85, 196608
    s_mul_i32 s85, s78, 12288
    s_add_u32 s38, s38, s85
    s_lshr_b32 s84, s2, 3
    s_cmp_eq_u32 s76, 0
    s_cbranch_scc0 L_MS_t1
    s_and_b32 s85, s2, 1
    s_lshl_b32 s85, s85, 2
    s_and_b32 s79, s2, 6
    s_xor_b32 s79, s79, s85
    s_add_u32 s79, s79, 2
    s_and_b32 s79, s79, 7
    v_lshrrev_b32 v3, 1, v7
    v_and_b32 v2, 1, v0
    v_lshlrev_b32_e64 v2, 7, v2
    v_lshl_add_u32 v2, v3, 10, v2
    s_lshl_b32 s85, s78, 2
    s_and_b32 s89, s84, 3
    s_add_u32 s85, s85, s89
    s_lshl_b32 s85, s85, 14
    s_lshl_b32 s79, s79, 7
    s_add_u32 s85, s85, s79
    s_bitcmp1_b32 s84, 2
    s_cselect_b64 s[44:45], s[12:13], s[10:11]
    s_branch L_MS_t9
L_MS_t1:
    s_cmp_eq_u32 s76, 1
    s_cbranch_scc0 L_MS_t2
    v_lshlrev_b32 v2, 7, v7
    s_lshr_b32 s85, s2, 1
    s_lshl_b32 s85, s85, 12
    s_bitcmp1_b32 s2, 0
    s_cselect_b64 s[44:45], s[16:17], s[14:15]
    s_branch L_MS_t9
L_MS_t2:
    s_cmp_eq_u32 s76, 2
    s_cbranch_scc0 L_MS_t3
    v_lshlrev_b32 v2, 6, v7
    s_lshl_b32 s85, s2, 11
    s_mov_b64 s[44:45], s[28:29]
    s_branch L_MS_t9
L_MS_t3:
    v_mul_u32_u24 v2, 3072, v7
    s_and_b32 s85, s84, 15
    s_mul_i32 s85, s85, 98304
    s_lshl_b32 s89, s78, 7
    s_add_u32 s85, s85, s89
    s_mov_b64 s[44:45], s[24:25]
L_MS_t9:
    v_add_u32 v24, s85, v2
    v_lshl_add_u32 v2, v0, 2, v9
    ds_write_b32 v2, v23
    v_bfe_u32 v2, v0, 1, 3
    v_xor_b32 v2, v2, v8
    v_lshlrev_b32 v2, 4, v2
    v_lshl_add_u32 v2, v7, 7, v2
    s_lshl_b32 s3, s87, 13
    s_lshl_b32 s85, s86, 12
    s_add_u32 s85, s85, 49152
    v_xor_b32 v3, 0, v2
    v_add_u32 v25, s3, v3
    v_add_u32 v29, s39, v3
    v_add_u32 v33, s85, v3
    v_xor_b32 v3, 32, v2
    v_add_u32 v26, s3, v3
    v_add_u32 v30, s39, v3
    v_add_u32 v34, s85, v3
    v_xor_b32 v3, 64, v2
    v_add_u32 v27, s3, v3
    v_add_u32 v31, s39, v3
    v_add_u32 v35, s85, v3
    v_xor_b32 v3, 96, v2
    v_add_u32 v28, s3, v3
    v_add_u32 v32, s39, v3
    v_add_u32_e64 v36, s85, v3
    v_bfe_u32 v2, v0, 3, 2
    v_bfe_u32 v3, v0, 1, 1
    v_lshl_add_u32 v2, v2, 1, v3
    v_bfe_u32 v3, v0, 2, 1
    v_xor_b32_e64 v4, v3, v8
    v_lshl_add_u32 v2, v4, 3, v2
    v_and_b32 v4, 1, v0
    v_lshlrev_b32 v4, 4, v4
    v_mov_b32 v5, 0x3f80
    v_lshlrev_b32_e64 v5, v4, v5
    v_cmp_eq_u32 s[94:95], 0, v2
    v_cmp_eq_u32 s[96:97], 1, v2
    s_nop 0
    v_cndmask_b32 v38, 0, v5, s[94:95]
    v_cndmask_b32 v39, 0, v5, s[96:97]
    v_cmp_eq_u32 s[94:95], 2, v2
    v_cmp_eq_u32 s[96:97], 3, v2
    s_nop 0
    v_cndmask_b32 v40, 0, v5, s[94:95]
    v_cndmask_b32 v41, 0, v5, s[96:97]
    v_cmp_eq_u32 s[94:95], 4, v2
    v_cmp_eq_u32 s[96:97], 5, v2
    s_nop 0
    v_cndmask_b32 v42, 0, v5, s[94:95]
    v_cndmask_b32 v43, 0, v5, s[96:97]
    v_cmp_eq_u32 s[94:95], 6, v2
    v_cmp_eq_u32 s[96:97], 7, v2
    s_nop 0
    v_cndmask_b32 v44, 0, v5, s[94:95]
    v_cndmask_b32 v45, 0, v5, s[96:97]
    v_xor_b32 v37, 8, v22
    s_cmp_lg_u32 s87, 0
    s_cselect_b64 s[94:95], -1, 0
    s_mov_b32 s96, 0
    s_mov_b32 s97, -1
    s_mov_b32 s83, 0xffffff00
    s_waitcnt lgkmcnt(0)
    s_add_u32 s0, s0, 0x9e3779b1
    s_mov_b32 s1, s0
    v_mov_b32 v46, s0
    v_mov_b32_e64 v47, s0
    v_and_b32 v48, 0xff, v46
    s_and_b32 s30, s0, 1
    s_xor_b32 s31, s30, 1
    s_mul_i32 s85, s86, 98304
    s_add_u32 s85, s85, s38
    s_add_u32 s85, s85, 12160
    v_mov_b32 v49, s85
    s_lshl_b32 s85, s86, 11
    s_add_u32 s85, s85, s38
    s_add_u32 s85, s85, 104320
    v_writelane_b32 v49, s85, 1
    s_lshl_b32 s85, s78, 1
    s_add_u32 s85, s85, s86
    s_lshl_b32 s85, s85, 4
    s_add_u32 s85, s85, s77
    s_lshl_b32 s85, s85, 1
    s_add_u32 s85, s85, s87
    s_lshl_b32 s85, s85, 7
    s_add_u32 s85, s85, 0x690000
    v_writelane_b32 v49, s85, 2
    s_mov_b64 exec, 7
    buffer_load_dword v49, v49, s[64:67], 0 offen
    s_mov_b64 exec, -1
    s_lshl_b32 s85, s81, 7
    v_mov_b32_e64 v50, s85
    global_load_dword v50, v50, s[20:21]
    s_lshl_b32 s85, s78, 1
    s_add_u32 s85, s85, s86
    s_lshl_b32 s85, s85, 12
    s_add_u32 s85, s85, 0x690000
    s_add_u32 s72, s36, s85
    s_addc_u32 s73, s37, 0
    s_mov_b32 s74, 4096
    s_mov_b32 s75, 0x20000
    s_lshl_b32 s85, s77, 8
    v_lshl_add_u32 v51, v7, 3, s85
    v_lshlrev_b32 v5, 8, v8
    v_sub_u32 v4, v51, v5
    v_subrev_u32 v92, 256, v4
    v_ashrrev_i32_e64 v100, 31, v92
    v_min_u32 v92, 0x10000, v92
    v_bfi_b32 v100, v100, 0, v48
    v_subrev_u32 v93, 768, v4
    v_ashrrev_i32_e64 v101, 31, v93
    v_min_u32 v93, 0x10000, v93
    v_bfi_b32 v101, v101, 0, v48
    v_subrev_u32 v94, 1280, v4
    v_ashrrev_i32_e64 v102, 31, v94
    v_min_u32 v94, 0x10000, v94
    v_bfi_b32 v102, v102, 0, v48
    v_subrev_u32 v95, 1792, v4
    v_ashrrev_i32_e64 v103, 31, v95
    v_min_u32 v95, 0x10000, v95
    v_bfi_b32 v103, v103, 0, v48
    v_subrev_u32 v96, 2304, v4
    v_ashrrev_i32_e64 v104, 31, v96
    v_min_u32 v96, 0x10000, v96
    v_bfi_b32 v104, v104, 0, v48
    v_subrev_u32 v97, 2816, v4
    v_ashrrev_i32_e64 v105, 31, v97
    v_min_u32 v97, 0x10000, v97
    v_bfi_b32 v105, v105, 0, v48
    v_subrev_u32 v98, 3328, v4
    v_ashrrev_i32_e64 v106, 31, v98
    v_min_u32 v98, 0x10000, v98
    v_bfi_b32 v106, v106, 0, v48
    v_subrev_u32 v99, 3840, v4
    v_ashrrev_i32_e64 v107, 31, v99
    v_min_u32 v99, 0x10000, v99
    v_bfi_b32 v107, v107, 0, v48
    s_lshl_b32 s85, s86, 9
    s_add_u32 s85, s85, 134144
    v_lshl_add_u32 v108, v7, 3, s85
    v_lshl_add_u32 v109, s87, 8, v108
    s_waitcnt vmcnt(2)
    v_lshlrev_b32 v18, 16, v18
    v_lshlrev_b32 v19, 16, v19
    v_lshlrev_b32 v20, 16, v20
    v_mul_f32 v10, s90, v20
    v_exp_f32 v10, v10
    s_nop 0
    v_cvt_pk_bf16_f32 v10, v10, v10
    v_lshlrev_b32 v10, 16, v10
    v_mul_f32 v12, v10, v18
    v_mul_f32 v13, v10, v19
    v_mul_f32 v12, s90, v12
    v_mul_f32 v13, 0.15915494, v13
    v_exp_f32 v10, v12
    v_rndne_f32 v11, v13
    v_sub_f32 v13, v13, v11
    v_cos_f32 v14, v13
    v_sin_f32 v15, v13
    v_mul_f32 v12, v18, v18
    v_mul_f32 v52, v10, v14
    v_mul_f32 v53, v10, v15
    v_fmac_f32 v12, v19, v19
    v_rcp_f32 v12, v12
    v_add_f32 v10, -1.0, v52
    v_mov_b32_e64 v11, v53
    v_xor_b32 v19, 0x80000000, v19
    v_add_f32_e64 v12, v12, v12
    v_pk_mul_f32 v[14:15], v[10:11], v[18:19] op_sel:[0,0] op_sel_hi:[0,1]
    v_pk_fma_f32 v[14:15], v[10:11], v[18:19], v[14:15] op_sel:[1,1,0] op_sel_hi:[1,0,1] neg_lo:[1,0,0]
    v_pk_mul_f32 v[74:75], v[12:13], v[14:15] op_sel:[0,0] op_sel_hi:[0,1]
    v_pk_mul_f32 v[54:55], v[52:53], v[52:53] op_sel:[0,0] op_sel_hi:[0,1]
    v_pk_fma_f32 v[54:55], v[52:53], v[52:53], v[54:55] op_sel:[1,1,0] op_sel_hi:[1,0,1] neg_lo:[1,0,0]
    v_pk_mul_f32 v[56:57], v[54:55], v[52:53] op_sel:[0,0] op_sel_hi:[0,1]
    v_pk_fma_f32 v[56:57], v[54:55], v[52:53], v[56:57] op_sel:[1,1,0] op_sel_hi:[1,0,1] neg_lo:[1,0,0]
    v_pk_mul_f32 v[58:59], v[56:57], v[52:53] op_sel:[0,0] op_sel_hi:[0,1]
    v_pk_fma_f32 v[58:59], v[56:57], v[52:53], v[58:59] op_sel:[1,1,0] op_sel_hi:[1,0,1] neg_lo:[1,0,0]
    v_pk_mul_f32 v[60:61], v[58:59], v[52:53] op_sel:[0,0] op_sel_hi:[0,1]
    v_pk_fma_f32 v[60:61], v[58:59], v[52:53], v[60:61] op_sel:[1,1,0] op_sel_hi:[1,0,1] neg_lo:[1,0,0]
    v_pk_mul_f32 v[62:63], v[60:61], v[52:53] op_sel:[0,0] op_sel_hi:[0,1]
    v_pk_fma_f32 v[62:63], v[60:61], v[52:53], v[62:63] op_sel:[1,1,0] op_sel_hi:[1,0,1] neg_lo:[1,0,0]
    v_pk_mul_f32 v[64:65], v[62:63], v[52:53] op_sel:[0,0] op_sel_hi:[0,1]
    v_pk_fma_f32 v[64:65], v[62:63], v[52:53], v[64:65] op_sel:[1,1,0] op_sel_hi:[1,0,1] neg_lo:[1,0,0]
    v_pk_mul_f32 v[66:67], v[64:65], v[52:53] op_sel:[0,0] op_sel_hi:[0,1]
    v_pk_fma_f32 v[66:67], v[64:65], v[52:53], v[66:67] op_sel:[1,1,0] op_sel_hi:[1,0,1] neg_lo:[1,0,0]
    v_pk_mul_f32 v[68:69], v[66:67], v[66:67] op_sel:[0,0] op_sel_hi:[0,1]
    v_pk_fma_f32 v[68:69], v[66:67], v[66:67], v[68:69] op_sel:[1,1,0] op_sel_hi:[1,0,1] neg_lo:[1,0,0]
    v_pk_mul_f32 v[70:71], v[68:69], v[68:69] op_sel:[0,0] op_sel_hi:[0,1]
    v_pk_fma_f32 v[70:71], v[68:69], v[68:69], v[70:71] op_sel:[1,1,0] op_sel_hi:[1,0,1] neg_lo:[1,0,0]
    v_pk_mul_f32 v[72:73], v[70:71], v[70:71] op_sel:[0,0] op_sel_hi:[0,1]
    v_pk_fma_f32 v[72:73], v[70:71], v[70:71], v[72:73] op_sel:[1,1,0] op_sel_hi:[1,0,1] neg_lo:[1,0,0]
    v_pk_mul_f32 v[10:11], v[72:73], v[72:73] op_sel:[0,0] op_sel_hi:[0,1]
    v_pk_fma_f32 v[10:11], v[72:73], v[72:73], v[10:11] op_sel:[1,1,0] op_sel_hi:[1,0,1] neg_lo:[1,0,0]
    v_pk_mul_f32 v[12:13], v[10:11], v[10:11] op_sel:[0,0] op_sel_hi:[0,1]
    v_pk_fma_f32 v[12:13], v[10:11], v[10:11], v[12:13] op_sel:[1,1,0] op_sel_hi:[1,0,1] neg_lo:[1,0,0]
    v_cndmask_b32 v76, 1.0, v10, s[96:97]
    v_cndmask_b32 v77, 0, v11, s[96:97]
    v_pk_mul_f32 v[78:79], v[76:77], v[12:13] op_sel:[0,0] op_sel_hi:[0,1]
    v_pk_fma_f32 v[78:79], v[76:77], v[12:13], v[78:79] op_sel:[1,1,0] op_sel_hi:[1,0,1] neg_lo:[1,0,0]
    v_pk_mul_f32 v[80:81], v[78:79], v[12:13] op_sel:[0,0] op_sel_hi:[0,1]
    v_pk_fma_f32 v[80:81], v[78:79], v[12:13], v[80:81] op_sel:[1,1,0] op_sel_hi:[1,0,1] neg_lo:[1,0,0]
    v_pk_mul_f32 v[82:83], v[80:81], v[12:13] op_sel:[0,0] op_sel_hi:[0,1]
    v_pk_fma_f32 v[82:83], v[80:81], v[12:13], v[82:83] op_sel:[1,1,0] op_sel_hi:[1,0,1] neg_lo:[1,0,0]
    v_pk_mul_f32 v[84:85], v[82:83], v[12:13] op_sel:[0,0] op_sel_hi:[0,1]
    v_pk_fma_f32 v[84:85], v[82:83], v[12:13], v[84:85] op_sel:[1,1,0] op_sel_hi:[1,0,1] neg_lo:[1,0,0]
    v_pk_mul_f32 v[86:87], v[84:85], v[12:13] op_sel:[0,0] op_sel_hi:[0,1]
    v_pk_fma_f32 v[86:87], v[84:85], v[12:13], v[86:87] op_sel:[1,1,0] op_sel_hi:[1,0,1] neg_lo:[1,0,0]
    v_pk_mul_f32 v[88:89], v[86:87], v[12:13] op_sel:[0,0] op_sel_hi:[0,1]
    v_pk_fma_f32 v[88:89], v[86:87], v[12:13], v[88:89] op_sel:[1,1,0] op_sel_hi:[1,0,1] neg_lo:[1,0,0]
    v_pk_mul_f32 v[90:91], v[88:89], v[12:13] op_sel:[0,0] op_sel_hi:[0,1]
    v_pk_fma_f32 v[90:91], v[88:89], v[12:13], v[90:91] op_sel:[1,1,0] op_sel_hi:[1,0,1] neg_lo:[1,0,0]
    s_barrier
    ds_read_b128 v[174:177], v25 offset:0
    ds_read_b128 v[182:185], v33 offset:0
    ds_read_b128 v[178:181], v25 offset:4096
    ds_read_b128 v[186:189], v33 offset:8192
    ds_read_b128 v[190:193], v26 offset:0
    ds_read_b128 v[198:201], v34 offset:0
    ds_read_b128 v[194:197], v26 offset:4096
    ds_read_b128 v[202:205], v34 offset:8192
    s_mov_b32 exec_hi, 0
    global_load_dword v24, v24, s[44:45]
    s_mov_b64 exec, -1
L_MS_ti15:
    s_waitcnt lgkmcnt(4)
    v_mfma_f32_32x32x16_bf16 v[110:125], v[174:177], v[182:185], 0
    v_mfma_f32_32x32x16_bf16 v[126:141], v[178:181], v[182:185], 0
    v_mfma_f32_32x32x16_bf16 v[142:157], v[174:177], v[186:189], 0
    v_mfma_f32_32x32x16_bf16 v[158:173], v[178:181], v[186:189], 0
    ds_read_b128 v[174:177], v27 offset:0
    ds_read_b128 v[182:185], v35 offset:0
    ds_read_b128 v[178:181], v27 offset:4096
    ds_read_b128 v[186:189], v35 offset:8192
    s_waitcnt lgkmcnt(4)
    v_mfma_f32_32x32x16_bf16 v[110:125], v[190:193], v[198:201], v[110:125]
    v_mfma_f32_32x32x16_bf16 v[126:141], v[194:197], v[198:201], v[126:141]
    v_mfma_f32_32x32x16_bf16 v[142:157], v[190:193], v[202:205], v[142:157]
    v_mfma_f32_32x32x16_bf16 v[158:173], v[194:197], v[202:205], v[158:173]
    ds_read_b128 v[190:193], v28 offset:0
    ds_read_b128 v[198:201], v36 offset:0
    ds_read_b128 v[194:197], v28 offset:4096
    ds_read_b128 v[202:205], v36 offset:8192
    s_waitcnt lgkmcnt(4)
    v_mfma_f32_32x32x16_bf16 v[110:125], v[174:177], v[182:185], v[110:125]
    v_mfma_f32_32x32x16_bf16 v[126:141], v[178:181], v[182:185], v[126:141]
    v_mfma_f32_32x32x16_bf16 v[142:157], v[174:177], v[186:189], v[142:157]
    v_mfma_f32_32x32x16_bf16 v[158:173], v[178:181], v[186:189], v[158:173]
    s_waitcnt lgkmcnt(0)
    s_barrier
    ds_read_b128 v[174:177], v25 offset:16384
    ds_read_b128 v[182:185], v33 offset:16384
    ds_read_b128 v[178:181], v25 offset:20480
    ds_read_b128 v[186:189], v33 offset:24576
    v_mfma_f32_32x32x16_bf16 v[110:125], v[190:193], v[198:201], v[110:125]
    v_mfma_f32_32x32x16_bf16 v[126:141], v[194:197], v[198:201], v[126:141]
    v_mfma_f32_32x32x16_bf16 v[142:157], v[190:193], v[202:205], v[142:157]
    v_mfma_f32_32x32x16_bf16 v[158:173], v[194:197], v[202:205], v[158:173]
    ds_read_b128 v[190:193], v26 offset:16384
    ds_read_b128 v[198:201], v34 offset:16384
    ds_read_b128 v[194:197], v26 offset:20480
    ds_read_b128 v[202:205], v34 offset:24576
    s_waitcnt lgkmcnt(4)
    v_mfma_f32_32x32x16_bf16 v[110:125], v[174:177], v[182:185], v[110:125]
    v_mfma_f32_32x32x16_bf16 v[126:141], v[178:181], v[182:185], v[126:141]
    v_mfma_f32_32x32x16_bf16 v[142:157], v[174:177], v[186:189], v[142:157]
    v_mfma_f32_32x32x16_bf16 v[158:173], v[178:181], v[186:189], v[158:173]
    ds_read_b128 v[174:177], v27 offset:16384
    ds_read_b128 v[182:185], v35 offset:16384
    ds_read_b128 v[178:181], v27 offset:20480
    ds_read_b128 v[186:189], v35 offset:24576
    s_waitcnt lgkmcnt(4)
    v_mfma_f32_32x32x16_bf16 v[110:125], v[190:193], v[198:201], v[110:125]
    v_mfma_f32_32x32x16_bf16 v[126:141], v[194:197], v[198:201], v[126:141]
    v_mfma_f32_32x32x16_bf16 v[142:157], v[190:193], v[202:205], v[142:157]
    v_mfma_f32_32x32x16_bf16 v[158:173], v[194:197], v[202:205], v[158:173]
    ds_read_b128 v[190:193], v28 offset:16384
    ds_read_b128 v[198:201], v36 offset:16384
    ds_read_b128 v[194:197], v28 offset:20480
    ds_read_b128 v[202:205], v36 offset:24576
    s_waitcnt lgkmcnt(4)
    v_mfma_f32_32x32x16_bf16 v[110:125], v[174:177], v[182:185], v[110:125]
    v_mfma_f32_32x32x16_bf16 v[126:141], v[178:181], v[182:185], v[126:141]
    v_mfma_f32_32x32x16_bf16 v[142:157], v[174:177], v[186:189], v[142:157]
    v_mfma_f32_32x32x16_bf16 v[158:173], v[178:181], v[186:189], v[158:173]
    s_waitcnt lgkmcnt(0)
    s_barrier
    ds_read_b128 v[174:177], v25 offset:32768
    ds_read_b128 v[182:185], v33 offset:32768
    ds_read_b128 v[178:181], v25 offset:36864
    ds_read_b128 v[186:189], v33 offset:40960
    v_mfma_f32_32x32x16_bf16 v[110:125], v[190:193], v[198:201], v[110:125]
    v_mfma_f32_32x32x16_bf16 v[126:141], v[194:197], v[198:201], v[126:141]
    v_mfma_f32_32x32x16_bf16 v[142:157], v[190:193], v[202:205], v[142:157]
    v_mfma_f32_32x32x16_bf16 v[158:173], v[194:197], v[202:205], v[158:173]
    ds_read_b128 v[190:193], v26 offset:32768
    ds_read_b128 v[198:201], v34 offset:32768
    ds_read_b128 v[194:197], v26 offset:36864
    ds_read_b128 v[202:205], v34 offset:40960
    s_waitcnt lgkmcnt(4)
    v_mfma_f32_32x32x16_bf16 v[110:125], v[174:177], v[182:185], v[110:125]
    v_mfma_f32_32x32x16_bf16 v[126:141], v[178:181], v[182:185], v[126:141]
    v_mfma_f32_32x32x16_bf16 v[142:157], v[174:177], v[186:189], v[142:157]
    v_mfma_f32_32x32x16_bf16 v[158:173], v[178:181], v[186:189], v[158:173]
    ds_read_b128 v[174:177], v27 offset:32768
    ds_read_b128 v[182:185], v35 offset:32768
    ds_read_b128 v[178:181], v27 offset:36864
    ds_read_b128 v[186:189], v35 offset:40960
    s_waitcnt lgkmcnt(4)
    v_mfma_f32_32x32x16_bf16 v[110:125], v[190:193], v[198:201], v[110:125]
    v_mfma_f32_32x32x16_bf16 v[126:141], v[194:197], v[198:201], v[126:141]
    v_mfma_f32_32x32x16_bf16 v[142:157], v[190:193], v[202:205], v[142:157]
    v_mfma_f32_32x32x16_bf16 v[158:173], v[194:197], v[202:205], v[158:173]
    ds_read_b128 v[190:193], v28 offset:32768
    ds_read_b128 v[198:201], v36 offset:32768
    ds_read_b128 v[194:197], v28 offset:36864
    ds_read_b128 v[202:205], v36 offset:40960
    s_waitcnt lgkmcnt(4)
    v_mfma_f32_32x32x16_bf16 v[110:125], v[174:177], v[182:185], v[110:125]
    v_mfma_f32_32x32x16_bf16 v[126:141], v[178:181], v[182:185], v[126:141]
    v_mfma_f32_32x32x16_bf16 v[142:157], v[174:177], v[186:189], v[142:157]
    v_mfma_f32_32x32x16_bf16 v[158:173], v[178:181], v[186:189], v[158:173]
    s_waitcnt lgkmcnt(0)
    s_barrier
    ds_read_b128 v[174:177], v25 offset:0
    ds_read_b128 v[182:185], v33 offset:0
    ds_read_b128 v[178:181], v25 offset:4096
    ds_read_b128 v[186:189], v33 offset:8192
    v_mfma_f32_32x32x16_bf16 v[110:125], v[190:193], v[198:201], v[110:125]
    v_mfma_f32_32x32x16_bf16 v[126:141], v[194:197], v[198:201], v[126:141]
    v_mfma_f32_32x32x16_bf16 v[142:157], v[190:193], v[202:205], v[142:157]
    v_mfma_f32_32x32x16_bf16 v[158:173], v[194:197], v[202:205], v[158:173]
    ds_read_b128 v[190:193], v26 offset:0
    ds_read_b128 v[198:201], v34 offset:0
    ds_read_b128 v[194:197], v26 offset:4096
    ds_read_b128 v[202:205], v34 offset:8192
    s_waitcnt lgkmcnt(4)
    v_mfma_f32_32x32x16_bf16 v[110:125], v[174:177], v[182:185], v[110:125]
    v_mfma_f32_32x32x16_bf16 v[126:141], v[178:181], v[182:185], v[126:141]
    v_mfma_f32_32x32x16_bf16 v[142:157], v[174:177], v[186:189], v[142:157]
    v_mfma_f32_32x32x16_bf16 v[158:173], v[178:181], v[186:189], v[158:173]
    ds_read_b128 v[174:177], v27 offset:0
    ds_read_b128 v[182:185], v35 offset:0
    ds_read_b128 v[178:181], v27 offset:4096
    ds_read_b128 v[186:189], v35 offset:8192
    s_waitcnt lgkmcnt(4)
    v_mfma_f32_32x32x16_bf16 v[110:125], v[190:193], v[198:201], v[110:125]
    v_mfma_f32_32x32x16_bf16 v[126:141], v[194:197], v[198:201], v[126:141]
    v_mfma_f32_32x32x16_bf16 v[142:157], v[190:193], v[202:205], v[142:157]
    v_mfma_f32_32x32x16_bf16 v[158:173], v[194:197], v[202:205], v[158:173]
    ds_read_b128 v[190:193], v28 offset:0
    ds_read_b128 v[198:201], v36 offset:0
    ds_read_b128 v[194:197], v28 offset:4096
    ds_read_b128 v[202:205], v36 offset:8192
    s_waitcnt lgkmcnt(4)
    v_mfma_f32_32x32x16_bf16 v[110:125], v[174:177], v[182:185], v[110:125]
    v_mfma_f32_32x32x16_bf16 v[126:141], v[178:181], v[182:185], v[126:141]
    v_mfma_f32_32x32x16_bf16 v[142:157], v[174:177], v[186:189], v[142:157]
    v_mfma_f32_32x32x16_bf16 v[158:173], v[178:181], v[186:189], v[158:173]
    s_waitcnt lgkmcnt(0)
    s_barrier
    ds_read_b128 v[174:177], v25 offset:16384
    ds_read_b128 v[182:185], v33 offset:16384
    ds_read_b128 v[178:181], v25 offset:20480
    ds_read_b128 v[186:189], v33 offset:24576
    v_mfma_f32_32x32x16_bf16 v[110:125], v[190:193], v[198:201], v[110:125]
    v_mfma_f32_32x32x16_bf16 v[126:141], v[194:197], v[198:201], v[126:141]
    v_mfma_f32_32x32x16_bf16 v[142:157], v[190:193], v[202:205], v[142:157]
    v_mfma_f32_32x32x16_bf16 v[158:173], v[194:197], v[202:205], v[158:173]
    ds_read_b128 v[190:193], v26 offset:16384
    ds_read_b128 v[198:201], v34 offset:16384
    ds_read_b128 v[194:197], v26 offset:20480
    ds_read_b128 v[202:205], v34 offset:24576
    s_waitcnt lgkmcnt(4)
    v_mfma_f32_32x32x16_bf16 v[110:125], v[174:177], v[182:185], v[110:125]
    v_mfma_f32_32x32x16_bf16 v[126:141], v[178:181], v[182:185], v[126:141]
    v_mfma_f32_32x32x16_bf16 v[142:157], v[174:177], v[186:189], v[142:157]
    v_mfma_f32_32x32x16_bf16 v[158:173], v[178:181], v[186:189], v[158:173]
    ds_read_b128 v[174:177], v27 offset:16384
    ds_read_b128 v[182:185], v35 offset:16384
    ds_read_b128 v[178:181], v27 offset:20480
    ds_read_b128 v[186:189], v35 offset:24576
    s_waitcnt lgkmcnt(4)
    v_mfma_f32_32x32x16_bf16 v[110:125], v[190:193], v[198:201], v[110:125]
    v_mfma_f32_32x32x16_bf16 v[126:141], v[194:197], v[198:201], v[126:141]
    v_mfma_f32_32x32x16_bf16 v[142:157], v[190:193], v[202:205], v[142:157]
    v_mfma_f32_32x32x16_bf16 v[158:173], v[194:197], v[202:205], v[158:173]
    ds_read_b128 v[190:193], v28 offset:16384
    ds_read_b128 v[198:201], v36 offset:16384
    ds_read_b128 v[194:197], v28 offset:20480
    ds_read_b128 v[202:205], v36 offset:24576
    s_waitcnt lgkmcnt(4)
    v_mfma_f32_32x32x16_bf16 v[110:125], v[174:177], v[182:185], v[110:125]
    v_mfma_f32_32x32x16_bf16 v[126:141], v[178:181], v[182:185], v[126:141]
    v_mfma_f32_32x32x16_bf16 v[142:157], v[174:177], v[186:189], v[142:157]
    v_mfma_f32_32x32x16_bf16 v[158:173], v[178:181], v[186:189], v[158:173]
    s_waitcnt lgkmcnt(0)
    s_barrier
    ds_read_b128 v[174:177], v25 offset:32768
    ds_read_b128 v[182:185], v33 offset:32768
    ds_read_b128 v[178:181], v25 offset:36864
    ds_read_b128 v[186:189], v33 offset:40960
    v_mfma_f32_32x32x16_bf16 v[110:125], v[190:193], v[198:201], v[110:125]
    v_mfma_f32_32x32x16_bf16 v[126:141], v[194:197], v[198:201], v[126:141]
    v_mfma_f32_32x32x16_bf16 v[142:157], v[190:193], v[202:205], v[142:157]
    v_mfma_f32_32x32x16_bf16 v[158:173], v[194:197], v[202:205], v[158:173]
    ds_read_b128 v[190:193], v26 offset:32768
    ds_read_b128 v[198:201], v34 offset:32768
    ds_read_b128 v[194:197], v26 offset:36864
    ds_read_b128 v[202:205], v34 offset:40960
    s_waitcnt lgkmcnt(4)
    v_mfma_f32_32x32x16_bf16 v[110:125], v[174:177], v[182:185], v[110:125]
    v_mfma_f32_32x32x16_bf16 v[126:141], v[178:181], v[182:185], v[126:141]
    v_mfma_f32_32x32x16_bf16 v[142:157], v[174:177], v[186:189], v[142:157]
    v_mfma_f32_32x32x16_bf16 v[158:173], v[178:181], v[186:189], v[158:173]
    ds_read_b128 v[174:177], v27 offset:32768
    ds_read_b128 v[182:185], v35 offset:32768
    ds_read_b128 v[178:181], v27 offset:36864
    ds_read_b128 v[186:189], v35 offset:40960
    s_waitcnt lgkmcnt(4)
    v_mfma_f32_32x32x16_bf16 v[110:125], v[190:193], v[198:201], v[110:125]
    v_mfma_f32_32x32x16_bf16 v[126:141], v[194:197], v[198:201], v[126:141]
    v_mfma_f32_32x32x16_bf16 v[142:157], v[190:193], v[202:205], v[142:157]
    v_mfma_f32_32x32x16_bf16 v[158:173], v[194:197], v[202:205], v[158:173]
    ds_read_b128 v[190:193], v28 offset:32768
    ds_read_b128 v[198:201], v36 offset:32768
    ds_read_b128 v[194:197], v28 offset:36864
    ds_read_b128 v[202:205], v36 offset:40960
    s_waitcnt lgkmcnt(4)
    v_mfma_f32_32x32x16_bf16 v[110:125], v[174:177], v[182:185], v[110:125]
    v_mfma_f32_32x32x16_bf16 v[126:141], v[178:181], v[182:185], v[126:141]
    v_mfma_f32_32x32x16_bf16 v[142:157], v[174:177], v[186:189], v[142:157]
    v_mfma_f32_32x32x16_bf16 v[158:173], v[178:181], v[186:189], v[158:173]
    s_waitcnt lgkmcnt(0)
    s_barrier
    ds_read_b128 v[174:177], v25 offset:0
    ds_read_b128 v[182:185], v33 offset:0
    ds_read_b128 v[178:181], v25 offset:4096
    ds_read_b128 v[186:189], v33 offset:8192
    v_mfma_f32_32x32x16_bf16 v[110:125], v[190:193], v[198:201], v[110:125]
    v_mfma_f32_32x32x16_bf16 v[126:141], v[194:197], v[198:201], v[126:141]
    v_mfma_f32_32x32x16_bf16 v[142:157], v[190:193], v[202:205], v[142:157]
    v_mfma_f32_32x32x16_bf16 v[158:173], v[194:197], v[202:205], v[158:173]
    ds_read_b128 v[190:193], v26 offset:0
    ds_read_b128 v[198:201], v34 offset:0
    ds_read_b128 v[194:197], v26 offset:4096
    ds_read_b128 v[202:205], v34 offset:8192
    s_waitcnt lgkmcnt(4)
    v_mfma_f32_32x32x16_bf16 v[110:125], v[174:177], v[182:185], v[110:125]
    v_mfma_f32_32x32x16_bf16 v[126:141], v[178:181], v[182:185], v[126:141]
    v_mfma_f32_32x32x16_bf16 v[142:157], v[174:177], v[186:189], v[142:157]
    v_mfma_f32_32x32x16_bf16 v[158:173], v[178:181], v[186:189], v[158:173]
    ds_read_b128 v[174:177], v27 offset:0
    ds_read_b128 v[182:185], v35 offset:0
    ds_read_b128 v[178:181], v27 offset:4096
    ds_read_b128 v[186:189], v35 offset:8192
    s_waitcnt lgkmcnt(4)
    v_mfma_f32_32x32x16_bf16 v[110:125], v[190:193], v[198:201], v[110:125]
    v_mfma_f32_32x32x16_bf16 v[126:141], v[194:197], v[198:201], v[126:141]
    v_mfma_f32_32x32x16_bf16 v[142:157], v[190:193], v[202:205], v[142:157]
    v_mfma_f32_32x32x16_bf16 v[158:173], v[194:197], v[202:205], v[158:173]
    ds_read_b128 v[190:193], v28 offset:0
    ds_read_b128 v[198:201], v36 offset:0
    ds_read_b128 v[194:197], v28 offset:4096
    ds_read_b128 v[202:205], v36 offset:8192
    s_waitcnt lgkmcnt(4)
    v_mfma_f32_32x32x16_bf16 v[110:125], v[174:177], v[182:185], v[110:125]
    v_mfma_f32_32x32x16_bf16 v[126:141], v[178:181], v[182:185], v[126:141]
    v_mfma_f32_32x32x16_bf16 v[142:157], v[174:177], v[186:189], v[142:157]
    v_mfma_f32_32x32x16_bf16 v[158:173], v[178:181], v[186:189], v[158:173]
    s_waitcnt lgkmcnt(0)
    s_barrier
    ds_read_b128 v[174:177], v25 offset:16384
    ds_read_b128 v[182:185], v33 offset:16384
    ds_read_b128 v[178:181], v25 offset:20480
    ds_read_b128 v[186:189], v33 offset:24576
    v_mfma_f32_32x32x16_bf16 v[110:125], v[190:193], v[198:201], v[110:125]
    v_mfma_f32_32x32x16_bf16 v[126:141], v[194:197], v[198:201], v[126:141]
    v_mfma_f32_32x32x16_bf16 v[142:157], v[190:193], v[202:205], v[142:157]
    v_mfma_f32_32x32x16_bf16 v[158:173], v[194:197], v[202:205], v[158:173]
    ds_read_b128 v[190:193], v26 offset:16384
    ds_read_b128 v[198:201], v34 offset:16384
    ds_read_b128 v[194:197], v26 offset:20480
    ds_read_b128 v[202:205], v34 offset:24576
    s_waitcnt lgkmcnt(4)
    v_mfma_f32_32x32x16_bf16 v[110:125], v[174:177], v[182:185], v[110:125]
    v_mfma_f32_32x32x16_bf16 v[126:141], v[178:181], v[182:185], v[126:141]
    v_mfma_f32_32x32x16_bf16 v[142:157], v[174:177], v[186:189], v[142:157]
    v_mfma_f32_32x32x16_bf16 v[158:173], v[178:181], v[186:189], v[158:173]
    ds_read_b128 v[174:177], v27 offset:16384
    ds_read_b128 v[182:185], v35 offset:16384
    ds_read_b128 v[178:181], v27 offset:20480
    ds_read_b128 v[186:189], v35 offset:24576
    s_waitcnt lgkmcnt(4)
    v_mfma_f32_32x32x16_bf16 v[110:125], v[190:193], v[198:201], v[110:125]
    v_mfma_f32_32x32x16_bf16 v[126:141], v[194:197], v[198:201], v[126:141]
    v_mfma_f32_32x32x16_bf16 v[142:157], v[190:193], v[202:205], v[142:157]
    v_mfma_f32_32x32x16_bf16 v[158:173], v[194:197], v[202:205], v[158:173]
    ds_read_b128 v[190:193], v28 offset:16384
    ds_read_b128 v[198:201], v36 offset:16384
    ds_read_b128 v[194:197], v28 offset:20480
    ds_read_b128 v[202:205], v36 offset:24576
    s_waitcnt lgkmcnt(4)
    v_mfma_f32_32x32x16_bf16 v[110:125], v[174:177], v[182:185], v[110:125]
    v_mfma_f32_32x32x16_bf16 v[126:141], v[178:181], v[182:185], v[126:141]
    v_mfma_f32_32x32x16_bf16 v[142:157], v[174:177], v[186:189], v[142:157]
    v_mfma_f32_32x32x16_bf16 v[158:173], v[178:181], v[186:189], v[158:173]
    s_waitcnt lgkmcnt(0)
    s_mov_b64 exec, 1
    ds_write_b32 v22, v9 offset:0
    s_mov_b64 exec, -1
    v_mfma_f32_32x32x16_bf16 v[110:125], v[190:193], v[198:201], v[110:125]
    v_mfma_f32_32x32x16_bf16 v[126:141], v[194:197], v[198:201], v[126:141]
    v_mfma_f32_32x32x16_bf16 v[142:157], v[190:193], v[202:205], v[142:157]
    v_mfma_f32_32x32x16_bf16 v[158:173], v[194:197], v[202:205], v[158:173]
    s_nop 8
    s_nop 0
    v_pk_fma_f32 v[112:113], v[52:53], v[110:111], v[112:113] op_sel:[0,0,0] op_sel_hi:[0,1,1]
    v_pk_fma_f32 v[128:129], v[52:53], v[126:127], v[128:129] op_sel:[0,0,0] op_sel_hi:[0,1,1]
    v_pk_fma_f32 v[144:145], v[52:53], v[142:143], v[144:145] op_sel:[0,0,0] op_sel_hi:[0,1,1]
    v_pk_fma_f32 v[160:161], v[52:53], v[158:159], v[160:161] op_sel:[0,0,0] op_sel_hi:[0,1,1]
    v_pk_fma_f32 v[112:113], v[52:53], v[142:143], v[112:113] op_sel:[1,0,0] op_sel_hi:[1,1,1] neg_lo:[1,0,0] neg_hi:[1,0,0]
    v_pk_fma_f32 v[128:129], v[52:53], v[158:159], v[128:129] op_sel:[1,0,0] op_sel_hi:[1,1,1] neg_lo:[1,0,0] neg_hi:[1,0,0]
    v_pk_fma_f32 v[144:145], v[52:53], v[110:111], v[144:145] op_sel:[1,0,0] op_sel_hi:[1,1,1]
    v_pk_fma_f32 v[160:161], v[52:53], v[126:127], v[160:161] op_sel:[1,0,0] op_sel_hi:[1,1,1]
    v_pk_fma_f32 v[114:115], v[52:53], v[112:113], v[114:115] op_sel:[0,0,0] op_sel_hi:[0,1,1]
    v_pk_fma_f32 v[130:131], v[52:53], v[128:129], v[130:131] op_sel:[0,0,0] op_sel_hi:[0,1,1]
    v_pk_fma_f32 v[146:147], v[52:53], v[144:145], v[146:147] op_sel:[0,0,0] op_sel_hi:[0,1,1]
    v_pk_fma_f32 v[162:163], v[52:53], v[160:161], v[162:163] op_sel:[0,0,0] op_sel_hi:[0,1,1]
    v_pk_fma_f32 v[114:115], v[52:53], v[144:145], v[114:115] op_sel:[1,0,0] op_sel_hi:[1,1,1] neg_lo:[1,0,0] neg_hi:[1,0,0]
    v_pk_fma_f32 v[130:131], v[52:53], v[160:161], v[130:131] op_sel:[1,0,0] op_sel_hi:[1,1,1] neg_lo:[1,0,0] neg_hi:[1,0,0]
    v_pk_fma_f32 v[146:147], v[52:53], v[112:113], v[146:147] op_sel:[1,0,0] op_sel_hi:[1,1,1]
    v_pk_fma_f32 v[162:163], v[52:53], v[128:129], v[162:163] op_sel:[1,0,0] op_sel_hi:[1,1,1]
    v_pk_fma_f32 v[116:117], v[52:53], v[114:115], v[116:117] op_sel:[0,0,0] op_sel_hi:[0,1,1]
    v_pk_fma_f32 v[132:133], v[52:53], v[130:131], v[132:133] op_sel:[0,0,0] op_sel_hi:[0,1,1]
    v_pk_fma_f32 v[148:149], v[52:53], v[146:147], v[148:149] op_sel:[0,0,0] op_sel_hi:[0,1,1]
    v_pk_fma_f32 v[164:165], v[52:53], v[162:163], v[164:165] op_sel:[0,0,0] op_sel_hi:[0,1,1]
    v_pk_fma_f32 v[116:117], v[52:53], v[146:147], v[116:117] op_sel:[1,0,0] op_sel_hi:[1,1,1] neg_lo:[1,0,0] neg_hi:[1,0,0]
    v_pk_fma_f32 v[132:133], v[52:53], v[162:163], v[132:133] op_sel:[1,0,0] op_sel_hi:[1,1,1] neg_lo:[1,0,0] neg_hi:[1,0,0]
    v_pk_fma_f32 v[148:149], v[52:53], v[114:115], v[148:149] op_sel:[1,0,0] op_sel_hi:[1,1,1]
    v_pk_fma_f32 v[164:165], v[52:53], v[130:131], v[164:165] op_sel:[1,0,0] op_sel_hi:[1,1,1]
    v_pk_fma_f32 v[118:119], v[52:53], v[116:117], v[118:119] op_sel:[0,0,0] op_sel_hi:[0,1,1]
    v_pk_fma_f32 v[134:135], v[52:53], v[132:133], v[134:135] op_sel:[0,0,0] op_sel_hi:[0,1,1]
    v_pk_fma_f32 v[150:151], v[52:53], v[148:149], v[150:151] op_sel:[0,0,0] op_sel_hi:[0,1,1]
    v_pk_fma_f32 v[166:167], v[52:53], v[164:165], v[166:167] op_sel:[0,0,0] op_sel_hi:[0,1,1]
    v_pk_fma_f32 v[118:119], v[52:53], v[148:149], v[118:119] op_sel:[1,0,0] op_sel_hi:[1,1,1] neg_lo:[1,0,0] neg_hi:[1,0,0]
    v_pk_fma_f32 v[134:135], v[52:53], v[164:165], v[134:135] op_sel:[1,0,0] op_sel_hi:[1,1,1] neg_lo:[1,0,0] neg_hi:[1,0,0]
    v_pk_fma_f32 v[150:151], v[52:53], v[116:117], v[150:151] op_sel:[1,0,0] op_sel_hi:[1,1,1]
    v_pk_fma_f32 v[166:167], v[52:53], v[132:133], v[166:167] op_sel:[1,0,0] op_sel_hi:[1,1,1]
    v_pk_fma_f32 v[120:121], v[52:53], v[118:119], v[120:121] op_sel:[0,0,0] op_sel_hi:[0,1,1]
    v_pk_fma_f32 v[136:137], v[52:53], v[134:135], v[136:137] op_sel:[0,0,0] op_sel_hi:[0,1,1]
    v_pk_fma_f32 v[152:153], v[52:53], v[150:151], v[152:153] op_sel:[0,0,0] op_sel_hi:[0,1,1]
    v_pk_fma_f32 v[168:169], v[52:53], v[166:167], v[168:169] op_sel:[0,0,0] op_sel_hi:[0,1,1]
    v_pk_fma_f32 v[120:121], v[52:53], v[150:151], v[120:121] op_sel:[1,0,0] op_sel_hi:[1,1,1] neg_lo:[1,0,0] neg_hi:[1,0,0]
    v_pk_fma_f32 v[136:137], v[52:53], v[166:167], v[136:137] op_sel:[1,0,0] op_sel_hi:[1,1,1] neg_lo:[1,0,0] neg_hi:[1,0,0]
    v_pk_fma_f32 v[152:153], v[52:53], v[118:119], v[152:153] op_sel:[1,0,0] op_sel_hi:[1,1,1]
    v_pk_fma_f32 v[168:169], v[52:53], v[134:135], v[168:169] op_sel:[1,0,0] op_sel_hi:[1,1,1]
    v_pk_fma_f32 v[122:123], v[52:53], v[120:121], v[122:123] op_sel:[0,0,0] op_sel_hi:[0,1,1]
    v_pk_fma_f32 v[138:139], v[52:53], v[136:137], v[138:139] op_sel:[0,0,0] op_sel_hi:[0,1,1]
    v_pk_fma_f32 v[154:155], v[52:53], v[152:153], v[154:155] op_sel:[0,0,0] op_sel_hi:[0,1,1]
    v_pk_fma_f32 v[170:171], v[52:53], v[168:169], v[170:171] op_sel:[0,0,0] op_sel_hi:[0,1,1]
    v_pk_fma_f32 v[122:123], v[52:53], v[152:153], v[122:123] op_sel:[1,0,0] op_sel_hi:[1,1,1] neg_lo:[1,0,0] neg_hi:[1,0,0]
    v_pk_fma_f32 v[138:139], v[52:53], v[168:169], v[138:139] op_sel:[1,0,0] op_sel_hi:[1,1,1] neg_lo:[1,0,0] neg_hi:[1,0,0]
    v_pk_fma_f32 v[154:155], v[52:53], v[120:121], v[154:155] op_sel:[1,0,0] op_sel_hi:[1,1,1]
    v_pk_fma_f32 v[170:171], v[52:53], v[136:137], v[170:171] op_sel:[1,0,0] op_sel_hi:[1,1,1]
    v_pk_fma_f32 v[124:125], v[52:53], v[122:123], v[124:125] op_sel:[0,0,0] op_sel_hi:[0,1,1]
    v_pk_fma_f32 v[140:141], v[52:53], v[138:139], v[140:141] op_sel:[0,0,0] op_sel_hi:[0,1,1]
    v_pk_fma_f32 v[156:157], v[52:53], v[154:155], v[156:157] op_sel:[0,0,0] op_sel_hi:[0,1,1]
    v_pk_fma_f32 v[172:173], v[52:53], v[170:171], v[172:173] op_sel:[0,0,0] op_sel_hi:[0,1,1]
    v_pk_fma_f32 v[124:125], v[52:53], v[154:155], v[124:125] op_sel:[1,0,0] op_sel_hi:[1,1,1] neg_lo:[1,0,0] neg_hi:[1,0,0]
    v_pk_fma_f32 v[140:141], v[52:53], v[170:171], v[140:141] op_sel:[1,0,0] op_sel_hi:[1,1,1] neg_lo:[1,0,0] neg_hi:[1,0,0]
    v_pk_fma_f32 v[156:157], v[52:53], v[122:123], v[156:157] op_sel:[1,0,0] op_sel_hi:[1,1,1]
    v_pk_fma_f32 v[172:173], v[52:53], v[138:139], v[172:173] op_sel:[1,0,0] op_sel_hi:[1,1,1]
    v_fma_f32 v10, v66, v124, v125
    v_fma_f32 v11, v66, v156, v157
    v_fma_f32 v12, v66, v140, v141
    v_fma_f32 v13, v66, v172, v173
    v_fma_f32 v10, -v67, v156, v10
    v_fma_f32 v11, v67, v124, v11
    v_fma_f32 v12, -v67, v172, v12
    v_fma_f32 v13, v67, v140, v13
    v_mov_b32 v14, v10
    v_mov_b32 v15, v11
    v_mov_b32 v16, v12
    v_mov_b32 v17, v13
    v_permlane32_swap_b32 v10, v14
    v_permlane32_swap_b32 v11, v15
    v_permlane32_swap_b32 v12, v16
    v_permlane32_swap_b32 v13, v17
    v_pk_fma_f32 v[18:19], v[68:69], v[10:11], v[14:15] op_sel:[0,0,0] op_sel_hi:[0,1,1]
    v_pk_fma_f32 v[18:19], v[68:69], v[10:11], v[18:19] op_sel:[1,1,0] op_sel_hi:[1,0,1] neg_lo:[1,0,0]
    v_pk_fma_f32 v[20:21], v[68:69], v[12:13], v[16:17] op_sel:[0,0,0] op_sel_hi:[0,1,1]
    v_pk_fma_f32 v[20:21], v[68:69], v[12:13], v[20:21] op_sel:[1,1,0] op_sel_hi:[1,0,1] neg_lo:[1,0,0]
    v_pk_fma_f32 v[26:27], v[70:71], v[18:19], v[20:21] op_sel:[0,0,0] op_sel_hi:[0,1,1]
    v_pk_fma_f32 v[26:27], v[70:71], v[18:19], v[26:27] op_sel:[1,1,0] op_sel_hi:[1,0,1] neg_lo:[1,0,0]
    ds_write_b64 v109, v[26:27]
    s_mov_b64 exec, 1
    ds_write_b32 v22, v9 offset:64
    s_mov_b64 exec, -1
    s_lshl_b32 s85, s87, 4
L_MS_s2:
    ds_read_b32 v2, v37 offset:64
    ds_read_b64 v[174:175], v108
    ds_read_b64 v[176:177], v108 offset:256
    s_waitcnt lgkmcnt(2)
    v_cmp_eq_u32 vcc, 0, v2
    s_cbranch_vccnz L_MS_s2_r
L_MS_s2_d:
    s_waitcnt lgkmcnt(0)
    v_pk_fma_f32 v[26:27], v[72:73], v[174:175], v[176:177] op_sel:[0,0,0] op_sel_hi:[0,1,1]
    v_pk_fma_f32 v[26:27], v[72:73], v[174:175], v[26:27] op_sel:[1,1,0] op_sel_hi:[1,0,1] neg_lo:[1,0,0]
    v_and_or_b32 v26, v26, s83, v48
    v_and_or_b32 v27, v27, s83, v48
    s_lshl_b64 exec, 0xffff, s85
    buffer_store_dwordx2 v[26:27], v51, s[72:75], 0 offen sc1
    s_mov_b64 exec, -1
    v_pk_mul_f32 v[14:15], v[74:75], v[110:111] op_sel:[1,0] op_sel_hi:[1,1] neg_lo:[1,0] neg_hi:[1,0]
    v_pk_mul_f32 v[16:17], v[74:75], v[126:127] op_sel:[1,0] op_sel_hi:[1,1] neg_lo:[1,0] neg_hi:[1,0]
    v_pk_mul_f32 v[110:111], v[74:75], v[110:111] op_sel:[0,0] op_sel_hi:[0,1]
    v_pk_mul_f32 v[126:127], v[74:75], v[126:127] op_sel:[0,0] op_sel_hi:[0,1]
    v_pk_fma_f32 v[110:111], v[74:75], v[142:143], v[110:111] op_sel:[1,0,0] op_sel_hi:[1,1,1] neg_lo:[1,0,0] neg_hi:[1,0,0]
    v_pk_fma_f32 v[126:127], v[74:75], v[158:159], v[126:127] op_sel:[1,0,0] op_sel_hi:[1,1,1] neg_lo:[1,0,0] neg_hi:[1,0,0]
    v_pk_fma_f32 v[142:143], v[74:75], v[142:143], v[14:15] op_sel:[0,0,0] op_sel_hi:[0,1,1] neg_lo:[1,0,0] neg_hi:[1,0,0]
    v_pk_fma_f32 v[158:159], v[74:75], v[158:159], v[16:17] op_sel:[0,0,0] op_sel_hi:[0,1,1] neg_lo:[1,0,0] neg_hi:[1,0,0]
    v_pk_mul_f32 v[14:15], v[74:75], v[112:113] op_sel:[1,0] op_sel_hi:[1,1] neg_lo:[1,0] neg_hi:[1,0]
    v_pk_mul_f32 v[16:17], v[74:75], v[128:129] op_sel:[1,0] op_sel_hi:[1,1] neg_lo:[1,0] neg_hi:[1,0]
    v_pk_mul_f32 v[112:113], v[74:75], v[112:113] op_sel:[0,0] op_sel_hi:[0,1]
    v_pk_mul_f32 v[128:129], v[74:75], v[128:129] op_sel:[0,0] op_sel_hi:[0,1]
    v_pk_fma_f32 v[112:113], v[74:75], v[144:145], v[112:113] op_sel:[1,0,0] op_sel_hi:[1,1,1] neg_lo:[1,0,0] neg_hi:[1,0,0]
    v_pk_fma_f32 v[128:129], v[74:75], v[160:161], v[128:129] op_sel:[1,0,0] op_sel_hi:[1,1,1] neg_lo:[1,0,0] neg_hi:[1,0,0]
    v_pk_fma_f32 v[144:145], v[74:75], v[144:145], v[14:15] op_sel:[0,0,0] op_sel_hi:[0,1,1] neg_lo:[1,0,0] neg_hi:[1,0,0]
    v_pk_fma_f32 v[160:161], v[74:75], v[160:161], v[16:17] op_sel:[0,0,0] op_sel_hi:[0,1,1] neg_lo:[1,0,0] neg_hi:[1,0,0]
    v_pk_mul_f32 v[14:15], v[74:75], v[114:115] op_sel:[1,0] op_sel_hi:[1,1] neg_lo:[1,0] neg_hi:[1,0]
    v_pk_mul_f32 v[16:17], v[74:75], v[130:131] op_sel:[1,0] op_sel_hi:[1,1] neg_lo:[1,0] neg_hi:[1,0]
    v_pk_mul_f32 v[114:115], v[74:75], v[114:115] op_sel:[0,0] op_sel_hi:[0,1]
    v_pk_mul_f32 v[130:131], v[74:75], v[130:131] op_sel:[0,0] op_sel_hi:[0,1]
    v_pk_fma_f32 v[114:115], v[74:75], v[146:147], v[114:115] op_sel:[1,0,0] op_sel_hi:[1,1,1] neg_lo:[1,0,0] neg_hi:[1,0,0]
    v_pk_fma_f32 v[130:131], v[74:75], v[162:163], v[130:131] op_sel:[1,0,0] op_sel_hi:[1,1,1] neg_lo:[1,0,0] neg_hi:[1,0,0]
    v_pk_fma_f32 v[146:147], v[74:75], v[146:147], v[14:15] op_sel:[0,0,0] op_sel_hi:[0,1,1] neg_lo:[1,0,0] neg_hi:[1,0,0]
    v_pk_fma_f32 v[162:163], v[74:75], v[162:163], v[16:17] op_sel:[0,0,0] op_sel_hi:[0,1,1] neg_lo:[1,0,0] neg_hi:[1,0,0]
    v_pk_mul_f32 v[14:15], v[74:75], v[116:117] op_sel:[1,0] op_sel_hi:[1,1] neg_lo:[1,0] neg_hi:[1,0]
    v_pk_mul_f32 v[16:17], v[74:75], v[132:133] op_sel:[1,0] op_sel_hi:[1,1] neg_lo:[1,0] neg_hi:[1,0]
    v_pk_mul_f32 v[116:117], v[74:75], v[116:117] op_sel:[0,0] op_sel_hi:[0,1]
    v_pk_mul_f32 v[132:133], v[74:75], v[132:133] op_sel:[0,0] op_sel_hi:[0,1]
    v_pk_fma_f32 v[116:117], v[74:75], v[148:149], v[116:117] op_sel:[1,0,0] op_sel_hi:[1,1,1] neg_lo:[1,0,0] neg_hi:[1,0,0]
    v_pk_fma_f32 v[132:133], v[74:75], v[164:165], v[132:133] op_sel:[1,0,0] op_sel_hi:[1,1,1] neg_lo:[1,0,0] neg_hi:[1,0,0]
    v_pk_fma_f32 v[148:149], v[74:75], v[148:149], v[14:15] op_sel:[0,0,0] op_sel_hi:[0,1,1] neg_lo:[1,0,0] neg_hi:[1,0,0]
    v_pk_fma_f32 v[164:165], v[74:75], v[164:165], v[16:17] op_sel:[0,0,0] op_sel_hi:[0,1,1] neg_lo:[1,0,0] neg_hi:[1,0,0]
    v_pk_mul_f32 v[14:15], v[74:75], v[118:119] op_sel:[1,0] op_sel_hi:[1,1] neg_lo:[1,0] neg_hi:[1,0]
    v_pk_mul_f32 v[16:17], v[74:75], v[134:135] op_sel:[1,0] op_sel_hi:[1,1] neg_lo:[1,0] neg_hi:[1,0]
    v_pk_mul_f32 v[118:119], v[74:75], v[118:119] op_sel:[0,0] op_sel_hi:[0,1]
    v_pk_mul_f32 v[134:135], v[74:75], v[134:135] op_sel:[0,0] op_sel_hi:[0,1]
    v_pk_fma_f32 v[118:119], v[74:75], v[150:151], v[118:119] op_sel:[1,0,0] op_sel_hi:[1,1,1] neg_lo:[1,0,0] neg_hi:[1,0,0]
    v_pk_fma_f32 v[134:135], v[74:75], v[166:167], v[134:135] op_sel:[1,0,0] op_sel_hi:[1,1,1] neg_lo:[1,0,0] neg_hi:[1,0,0]
    v_pk_fma_f32 v[150:151], v[74:75], v[150:151], v[14:15] op_sel:[0,0,0] op_sel_hi:[0,1,1] neg_lo:[1,0,0] neg_hi:[1,0,0]
    v_pk_fma_f32 v[166:167], v[74:75], v[166:167], v[16:17] op_sel:[0,0,0] op_sel_hi:[0,1,1] neg_lo:[1,0,0] neg_hi:[1,0,0]
    v_pk_mul_f32 v[14:15], v[74:75], v[120:121] op_sel:[1,0] op_sel_hi:[1,1] neg_lo:[1,0] neg_hi:[1,0]
    v_pk_mul_f32 v[16:17], v[74:75], v[136:137] op_sel:[1,0] op_sel_hi:[1,1] neg_lo:[1,0] neg_hi:[1,0]
    v_pk_mul_f32 v[120:121], v[74:75], v[120:121] op_sel:[0,0] op_sel_hi:[0,1]
    v_pk_mul_f32 v[136:137], v[74:75], v[136:137] op_sel:[0,0] op_sel_hi:[0,1]
    v_pk_fma_f32 v[120:121], v[74:75], v[152:153], v[120:121] op_sel:[1,0,0] op_sel_hi:[1,1,1] neg_lo:[1,0,0] neg_hi:[1,0,0]
    v_pk_fma_f32 v[136:137], v[74:75], v[168:169], v[136:137] op_sel:[1,0,0] op_sel_hi:[1,1,1] neg_lo:[1,0,0] neg_hi:[1,0,0]
    v_pk_fma_f32 v[152:153], v[74:75], v[152:153], v[14:15] op_sel:[0,0,0] op_sel_hi:[0,1,1] neg_lo:[1,0,0] neg_hi:[1,0,0]
    v_pk_fma_f32 v[168:169], v[74:75], v[168:169], v[16:17] op_sel:[0,0,0] op_sel_hi:[0,1,1] neg_lo:[1,0,0] neg_hi:[1,0,0]
    v_pk_mul_f32 v[14:15], v[74:75], v[122:123] op_sel:[1,0] op_sel_hi:[1,1] neg_lo:[1,0] neg_hi:[1,0]
    v_pk_mul_f32 v[16:17], v[74:75], v[138:139] op_sel:[1,0] op_sel_hi:[1,1] neg_lo:[1,0] neg_hi:[1,0]
    v_pk_mul_f32 v[122:123], v[74:75], v[122:123] op_sel:[0,0] op_sel_hi:[0,1]
    v_pk_mul_f32 v[138:139], v[74:75], v[138:139] op_sel:[0,0] op_sel_hi:[0,1]
    v_pk_fma_f32 v[122:123], v[74:75], v[154:155], v[122:123] op_sel:[1,0,0] op_sel_hi:[1,1,1] neg_lo:[1,0,0] neg_hi:[1,0,0]
    v_pk_fma_f32 v[138:139], v[74:75], v[170:171], v[138:139] op_sel:[1,0,0] op_sel_hi:[1,1,1] neg_lo:[1,0,0] neg_hi:[1,0,0]
    v_pk_fma_f32 v[154:155], v[74:75], v[154:155], v[14:15] op_sel:[0,0,0] op_sel_hi:[0,1,1] neg_lo:[1,0,0] neg_hi:[1,0,0]
    v_pk_fma_f32 v[170:171], v[74:75], v[170:171], v[16:17] op_sel:[0,0,0] op_sel_hi:[0,1,1] neg_lo:[1,0,0] neg_hi:[1,0,0]
    v_pk_mul_f32 v[14:15], v[74:75], v[124:125] op_sel:[1,0] op_sel_hi:[1,1] neg_lo:[1,0] neg_hi:[1,0]
    v_pk_mul_f32 v[16:17], v[74:75], v[140:141] op_sel:[1,0] op_sel_hi:[1,1] neg_lo:[1,0] neg_hi:[1,0]
    v_pk_mul_f32 v[124:125], v[74:75], v[124:125] op_sel:[0,0] op_sel_hi:[0,1]
    v_pk_mul_f32 v[140:141], v[74:75], v[140:141] op_sel:[0,0] op_sel_hi:[0,1]
    v_pk_fma_f32 v[124:125], v[74:75], v[156:157], v[124:125] op_sel:[1,0,0] op_sel_hi:[1,1,1] neg_lo:[1,0,0] neg_hi:[1,0,0]
    v_pk_fma_f32 v[140:141], v[74:75], v[172:173], v[140:141] op_sel:[1,0,0] op_sel_hi:[1,1,1] neg_lo:[1,0,0] neg_hi:[1,0,0]
    v_pk_fma_f32 v[156:157], v[74:75], v[156:157], v[14:15] op_sel:[0,0,0] op_sel_hi:[0,1,1] neg_lo:[1,0,0] neg_hi:[1,0,0]
    v_pk_fma_f32 v[172:173], v[74:75], v[172:173], v[16:17] op_sel:[0,0,0] op_sel_hi:[0,1,1] neg_lo:[1,0,0] neg_hi:[1,0,0]
    v_cndmask_b32 v182, 0, v174, s[94:95]
    v_cndmask_b32 v183, 0, v175, s[94:95]
    v_pk_fma_f32 v[184:185], v[70:71], v[182:183], v[18:19] op_sel:[0,0,0] op_sel_hi:[0,1,1]
    v_pk_fma_f32 v[184:185], v[70:71], v[182:183], v[184:185] op_sel:[1,1,0] op_sel_hi:[1,0,1] neg_lo:[1,0,0]
    v_pk_fma_f32 v[178:179], v[68:69], v[182:183], v[10:11] op_sel:[0,0,0] op_sel_hi:[0,1,1]
    v_pk_fma_f32 v[178:179], v[68:69], v[182:183], v[178:179] op_sel:[1,1,0] op_sel_hi:[1,0,1] neg_lo:[1,0,0]
    v_pk_fma_f32 v[180:181], v[68:69], v[184:185], v[12:13] op_sel:[0,0,0] op_sel_hi:[0,1,1]
    v_pk_fma_f32 v[180:181], v[68:69], v[184:185], v[180:181] op_sel:[1,1,0] op_sel_hi:[1,0,1] neg_lo:[1,0,0]
    v_cndmask_b32 v182, v182, v178, s[96:97]
    v_cndmask_b32 v183, v183, v179, s[96:97]
    v_cndmask_b32 v184, v184, v180, s[96:97]
    v_cndmask_b32 v185, v185, v181, s[96:97]
    v_mul_f32 v34, v74, v182
    v_mul_f32 v186, v74, v183
    v_fma_f32 v34, -v75, v183, v34
    v_fma_f32 v186, v75, v182, v186
    v_fma_f32 v35, v66, v34, v124
    v_fma_f32 v187, v66, v186, -v156
    v_fma_f32 v35, -v67, v186, v35
    v_fma_f32 v187, v67, v34, v187
    v_mul_f32 v108, v74, v184
    v_mul_f32 v188, v74, v185
    v_fma_f32 v108, -v75, v185, v108
    v_fma_f32 v188, v75, v184, v188
    v_fma_f32 v109, v66, v108, v140
    v_fma_f32 v189, v66, v188, -v172
    v_fma_f32 v109, -v67, v188, v109
    v_fma_f32 v189, v67, v108, v189
    v_cndmask_b32 v182, 1.0, v72, s[94:95]
    v_cndmask_b32 v183, 0, v73, s[94:95]
    v_pk_mul_f32 v[184:185], v[70:71], v[182:183] op_sel:[0,0] op_sel_hi:[0,1]
    v_pk_fma_f32 v[184:185], v[70:71], v[182:183], v[184:185] op_sel:[1,1,0] op_sel_hi:[1,0,1] neg_lo:[1,0,0]
    v_pk_mul_f32 v[178:179], v[68:69], v[182:183] op_sel:[0,0] op_sel_hi:[0,1]
    v_pk_fma_f32 v[178:179], v[68:69], v[182:183], v[178:179] op_sel:[1,1,0] op_sel_hi:[1,0,1] neg_lo:[1,0,0]
    v_pk_mul_f32 v[180:181], v[68:69], v[184:185] op_sel:[0,0] op_sel_hi:[0,1]
    v_pk_fma_f32 v[180:181], v[68:69], v[184:185], v[180:181] op_sel:[1,1,0] op_sel_hi:[1,0,1] neg_lo:[1,0,0]
    v_cndmask_b32 v182, v182, v178, s[96:97]
    v_cndmask_b32 v183, v183, v179, s[96:97]
    v_cndmask_b32 v184, v184, v180, s[96:97]
    v_cndmask_b32 v185, v185, v181, s[96:97]
    v_mul_f32 v190, v74, v182
    v_mul_f32 v194, v74, v183
    v_fma_f32 v190, -v75, v183, v190
    v_fma_f32 v194, v75, v182, v194
    v_fma_f32 v191, v66, v190, 0
    v_fma_f32 v195, v66, v194, 0
    v_fma_f32 v191, -v67, v194, v191
    v_fma_f32 v195, v67, v190, v195
    v_mul_f32 v192, v74, v184
    v_mul_f32 v196, v74, v185
    v_fma_f32 v192, -v75, v185, v192
    v_fma_f32 v196, v75, v184, v196
    v_fma_f32 v193, v66, v192, 0
    v_fma_f32 v197, v66, v196, 0
    v_fma_f32 v193, -v67, v196, v193
    v_fma_f32 v197, v67, v192, v197
    s_mov_b64 exec, 1
    ds_write_b32 v22, v9 offset:80
    s_mov_b64 exec, -1
    s_lshl_b32 s85, s86, 11
    s_add_u32 s22, s38, s85
    s_add_u32 s23, s22, 98304
    v_add_u32 v18, 4096, v6
    buffer_load_dwordx2 v[198:199], v92, s[72:75], 0 offen sc1
    buffer_load_dwordx2 v[200:201], v93, s[72:75], 0 offen sc1
    buffer_load_dwordx2 v[202:203], v94, s[72:75], 0 offen sc1
    buffer_load_dwordx2 v[204:205], v95, s[72:75], 0 offen sc1
    buffer_load_dwordx2 v[206:207], v96, s[72:75], 0 offen sc1
    buffer_load_dwordx2 v[208:209], v97, s[72:75], 0 offen sc1
    buffer_load_dwordx2 v[210:211], v98, s[72:75], 0 offen sc1
    buffer_load_dwordx2 v[212:213], v99, s[72:75], 0 offen sc1
    s_waitcnt vmcnt(0)
    s_nop 0
L_MS_e:
    v_bitop3_b32 v178, v198, v199, v100 bitop3:0x7e
    v_bitop3_b32 v179, v200, v201, v101 bitop3:0x7e
    v_bitop3_b32 v180, v202, v203, v102 bitop3:0x7e
    v_bitop3_b32 v181, v204, v205, v103 bitop3:0x7e
    v_bitop3_b32 v182, v206, v207, v104 bitop3:0x7e
    v_bitop3_b32 v183, v208, v209, v105 bitop3:0x7e
    v_bitop3_b32 v184, v210, v211, v106 bitop3:0x7e
    v_bitop3_b32 v185, v212, v213, v107 bitop3:0x7e
    v_or3_b32 v178, v178, v179, v180
    v_or3_b32 v182, v182, v183, v184
    v_or3_b32 v178, v178, v181, v185
    v_or_b32_e64 v178, v178, v182
    v_and_b32 v178, 0xff, v178
    v_cmp_ne_u32 vcc, 0, v178
    s_cbranch_vccnz L_MS_e_r
L_MS_e_d:
    v_pk_mul_f32 v[178:179], v[76:77], v[198:199] op_sel:[0,0] op_sel_hi:[0,1]
    v_pk_fma_f32 v[178:179], v[76:77], v[198:199], v[178:179] op_sel:[1,1,0] op_sel_hi:[1,0,1] neg_lo:[1,0,0]
    v_pk_fma_f32 v[178:179], v[78:79], v[200:201], v[178:179] op_sel:[0,0,0] op_sel_hi:[0,1,1]
    v_pk_fma_f32 v[178:179], v[78:79], v[200:201], v[178:179] op_sel:[1,1,0] op_sel_hi:[1,0,1] neg_lo:[1,0,0]
    v_pk_fma_f32 v[178:179], v[80:81], v[202:203], v[178:179] op_sel:[0,0,0] op_sel_hi:[0,1,1]
    v_pk_fma_f32 v[178:179], v[80:81], v[202:203], v[178:179] op_sel:[1,1,0] op_sel_hi:[1,0,1] neg_lo:[1,0,0]
    v_pk_fma_f32 v[178:179], v[82:83], v[204:205], v[178:179] op_sel:[0,0,0] op_sel_hi:[0,1,1]
    v_pk_fma_f32 v[178:179], v[82:83], v[204:205], v[178:179] op_sel:[1,1,0] op_sel_hi:[1,0,1] neg_lo:[1,0,0]
    v_pk_fma_f32 v[178:179], v[84:85], v[206:207], v[178:179] op_sel:[0,0,0] op_sel_hi:[0,1,1]
    v_pk_fma_f32 v[178:179], v[84:85], v[206:207], v[178:179] op_sel:[1,1,0] op_sel_hi:[1,0,1] neg_lo:[1,0,0]
    v_pk_fma_f32 v[178:179], v[86:87], v[208:209], v[178:179] op_sel:[0,0,0] op_sel_hi:[0,1,1]
    v_pk_fma_f32 v[178:179], v[86:87], v[208:209], v[178:179] op_sel:[1,1,0] op_sel_hi:[1,0,1] neg_lo:[1,0,0]
    v_pk_fma_f32 v[178:179], v[88:89], v[210:211], v[178:179] op_sel:[0,0,0] op_sel_hi:[0,1,1]
    v_pk_fma_f32 v[178:179], v[88:89], v[210:211], v[178:179] op_sel:[1,1,0] op_sel_hi:[1,0,1] neg_lo:[1,0,0]
    v_pk_fma_f32 v[178:179], v[90:91], v[212:213], v[178:179] op_sel:[0,0,0] op_sel_hi:[0,1,1]
    v_pk_fma_f32 v[178:179], v[90:91], v[212:213], v[178:179] op_sel:[1,1,0] op_sel_hi:[1,0,1] neg_lo:[1,0,0]
    v_mov_b32 v180, v178
    v_mov_b32 v181, v179
    s_nop 0
    v_permlane32_swap_b32 v178, v180
    v_permlane32_swap_b32_e64 v179, v181
    v_pk_add_f32 v[178:179], v[178:179], v[180:181]
    v_pk_fma_f32 v[34:35], v[178:179], v[190:191], v[34:35] op_sel:[0,0,0] op_sel_hi:[0,1,1]
    v_pk_fma_f32 v[186:187], v[178:179], v[194:195], v[186:187] op_sel:[0,0,0] op_sel_hi:[0,1,1]
    v_pk_fma_f32 v[34:35], v[178:179], v[194:195], v[34:35] op_sel:[1,0,0] op_sel_hi:[1,1,1] neg_lo:[1,0,0] neg_hi:[1,0,0]
    v_pk_fma_f32 v[186:187], v[178:179], v[190:191], v[186:187] op_sel:[1,0,0] op_sel_hi:[1,1,1]
    v_pk_fma_f32 v[108:109], v[178:179], v[192:193], v[108:109] op_sel:[0,0,0] op_sel_hi:[0,1,1]
    v_pk_fma_f32 v[188:189], v[178:179], v[196:197], v[188:189] op_sel:[0,0,0] op_sel_hi:[0,1,1]
    v_pk_fma_f32 v[108:109], v[178:179], v[196:197], v[108:109] op_sel:[1,0,0] op_sel_hi:[1,1,1] neg_lo:[1,0,0] neg_hi:[1,0,0]
    v_pk_fma_f32 v[188:189], v[178:179], v[192:193], v[188:189] op_sel:[1,0,0] op_sel_hi:[1,1,1]
    v_pk_fma_f32 v[110:111], v[52:53], v[34:35], v[110:111] op_sel:[0,0,0] op_sel_hi:[0,1,1]
    v_pk_fma_f32 v[112:113], v[54:55], v[34:35], v[112:113] op_sel:[0,0,0] op_sel_hi:[0,1,1]
    v_pk_fma_f32 v[114:115], v[56:57], v[34:35], v[114:115] op_sel:[0,0,0] op_sel_hi:[0,1,1]
    v_pk_fma_f32 v[116:117], v[58:59], v[34:35], v[116:117] op_sel:[0,0,0] op_sel_hi:[0,1,1]
    v_pk_fma_f32 v[118:119], v[60:61], v[34:35], v[118:119] op_sel:[0,0,0] op_sel_hi:[0,1,1]
    v_pk_fma_f32 v[120:121], v[62:63], v[34:35], v[120:121] op_sel:[0,0,0] op_sel_hi:[0,1,1]
    v_pk_fma_f32 v[122:123], v[64:65], v[34:35], v[122:123] op_sel:[0,0,0] op_sel_hi:[0,1,1]
    v_pk_fma_f32 v[124:125], v[66:67], v[34:35], v[124:125] op_sel:[0,0,0] op_sel_hi:[0,1,1]
    v_pk_fma_f32 v[110:111], v[52:53], v[186:187], v[110:111] op_sel:[1,0,0] op_sel_hi:[1,1,1] neg_lo:[1,0,0] neg_hi:[1,0,0]
    v_pk_fma_f32 v[112:113], v[54:55], v[186:187], v[112:113] op_sel:[1,0,0] op_sel_hi:[1,1,1] neg_lo:[1,0,0] neg_hi:[1,0,0]
    v_pk_fma_f32 v[114:115], v[56:57], v[186:187], v[114:115] op_sel:[1,0,0] op_sel_hi:[1,1,1] neg_lo:[1,0,0] neg_hi:[1,0,0]
    v_pk_fma_f32 v[116:117], v[58:59], v[186:187], v[116:117] op_sel:[1,0,0] op_sel_hi:[1,1,1] neg_lo:[1,0,0] neg_hi:[1,0,0]
    v_pk_fma_f32 v[118:119], v[60:61], v[186:187], v[118:119] op_sel:[1,0,0] op_sel_hi:[1,1,1] neg_lo:[1,0,0] neg_hi:[1,0,0]
    v_pk_fma_f32 v[120:121], v[62:63], v[186:187], v[120:121] op_sel:[1,0,0] op_sel_hi:[1,1,1] neg_lo:[1,0,0] neg_hi:[1,0,0]
    v_pk_fma_f32 v[122:123], v[64:65], v[186:187], v[122:123] op_sel:[1,0,0] op_sel_hi:[1,1,1] neg_lo:[1,0,0] neg_hi:[1,0,0]
    v_pk_fma_f32 v[124:125], v[66:67], v[186:187], v[124:125] op_sel:[1,0,0] op_sel_hi:[1,1,1] neg_lo:[1,0,0] neg_hi:[1,0,0]
    v_pk_fma_f32 v[142:143], v[52:53], v[186:187], v[142:143] op_sel:[0,0,0] op_sel_hi:[0,1,1] neg_lo:[1,0,0] neg_hi:[1,0,0]
    v_pk_fma_f32 v[144:145], v[54:55], v[186:187], v[144:145] op_sel:[0,0,0] op_sel_hi:[0,1,1] neg_lo:[1,0,0] neg_hi:[1,0,0]
    v_pk_fma_f32 v[146:147], v[56:57], v[186:187], v[146:147] op_sel:[0,0,0] op_sel_hi:[0,1,1] neg_lo:[1,0,0] neg_hi:[1,0,0]
    v_pk_fma_f32 v[148:149], v[58:59], v[186:187], v[148:149] op_sel:[0,0,0] op_sel_hi:[0,1,1] neg_lo:[1,0,0] neg_hi:[1,0,0]
    v_pk_fma_f32 v[150:151], v[60:61], v[186:187], v[150:151] op_sel:[0,0,0] op_sel_hi:[0,1,1] neg_lo:[1,0,0] neg_hi:[1,0,0]
    v_pk_fma_f32 v[152:153], v[62:63], v[186:187], v[152:153] op_sel:[0,0,0] op_sel_hi:[0,1,1] neg_lo:[1,0,0] neg_hi:[1,0,0]
    v_pk_fma_f32 v[154:155], v[64:65], v[186:187], v[154:155] op_sel:[0,0,0] op_sel_hi:[0,1,1] neg_lo:[1,0,0] neg_hi:[1,0,0]
    v_pk_fma_f32 v[156:157], v[66:67], v[186:187], v[156:157] op_sel:[0,0,0] op_sel_hi:[0,1,1] neg_lo:[1,0,0] neg_hi:[1,0,0]
    v_pk_fma_f32 v[142:143], v[52:53], v[34:35], v[142:143] op_sel:[1,0,0] op_sel_hi:[1,1,1] neg_lo:[1,0,0] neg_hi:[1,0,0]
    v_pk_fma_f32 v[144:145], v[54:55], v[34:35], v[144:145] op_sel:[1,0,0] op_sel_hi:[1,1,1] neg_lo:[1,0,0] neg_hi:[1,0,0]
    v_pk_fma_f32 v[146:147], v[56:57], v[34:35], v[146:147] op_sel:[1,0,0] op_sel_hi:[1,1,1] neg_lo:[1,0,0] neg_hi:[1,0,0]
    v_pk_fma_f32 v[148:149], v[58:59], v[34:35], v[148:149] op_sel:[1,0,0] op_sel_hi:[1,1,1] neg_lo:[1,0,0] neg_hi:[1,0,0]
    v_pk_fma_f32 v[150:151], v[60:61], v[34:35], v[150:151] op_sel:[1,0,0] op_sel_hi:[1,1,1] neg_lo:[1,0,0] neg_hi:[1,0,0]
    v_pk_fma_f32 v[152:153], v[62:63], v[34:35], v[152:153] op_sel:[1,0,0] op_sel_hi:[1,1,1] neg_lo:[1,0,0] neg_hi:[1,0,0]
    v_pk_fma_f32 v[154:155], v[64:65], v[34:35], v[154:155] op_sel:[1,0,0] op_sel_hi:[1,1,1] neg_lo:[1,0,0] neg_hi:[1,0,0]
    v_pk_fma_f32 v[156:157], v[66:67], v[34:35], v[156:157] op_sel:[1,0,0] op_sel_hi:[1,1,1] neg_lo:[1,0,0] neg_hi:[1,0,0]
    v_pk_fma_f32 v[126:127], v[52:53], v[108:109], v[126:127] op_sel:[0,0,0] op_sel_hi:[0,1,1]
    v_pk_fma_f32 v[128:129], v[54:55], v[108:109], v[128:129] op_sel:[0,0,0] op_sel_hi:[0,1,1]
    v_pk_fma_f32 v[130:131], v[56:57], v[108:109], v[130:131] op_sel:[0,0,0] op_sel_hi:[0,1,1]
    v_pk_fma_f32 v[132:133], v[58:59], v[108:109], v[132:133] op_sel:[0,0,0] op_sel_hi:[0,1,1]
    v_pk_fma_f32 v[134:135], v[60:61], v[108:109], v[134:135] op_sel:[0,0,0] op_sel_hi:[0,1,1]
    v_pk_fma_f32 v[136:137], v[62:63], v[108:109], v[136:137] op_sel:[0,0,0] op_sel_hi:[0,1,1]
    v_pk_fma_f32 v[138:139], v[64:65], v[108:109], v[138:139] op_sel:[0,0,0] op_sel_hi:[0,1,1]
    v_pk_fma_f32 v[140:141], v[66:67], v[108:109], v[140:141] op_sel:[0,0,0] op_sel_hi:[0,1,1]
    v_pk_fma_f32 v[126:127], v[52:53], v[188:189], v[126:127] op_sel:[1,0,0] op_sel_hi:[1,1,1] neg_lo:[1,0,0] neg_hi:[1,0,0]
    v_pk_fma_f32 v[128:129], v[54:55], v[188:189], v[128:129] op_sel:[1,0,0] op_sel_hi:[1,1,1] neg_lo:[1,0,0] neg_hi:[1,0,0]
    v_pk_fma_f32 v[130:131], v[56:57], v[188:189], v[130:131] op_sel:[1,0,0] op_sel_hi:[1,1,1] neg_lo:[1,0,0] neg_hi:[1,0,0]
    v_pk_fma_f32 v[132:133], v[58:59], v[188:189], v[132:133] op_sel:[1,0,0] op_sel_hi:[1,1,1] neg_lo:[1,0,0] neg_hi:[1,0,0]
    v_pk_fma_f32 v[134:135], v[60:61], v[188:189], v[134:135] op_sel:[1,0,0] op_sel_hi:[1,1,1] neg_lo:[1,0,0] neg_hi:[1,0,0]
    v_pk_fma_f32 v[136:137], v[62:63], v[188:189], v[136:137] op_sel:[1,0,0] op_sel_hi:[1,1,1] neg_lo:[1,0,0] neg_hi:[1,0,0]
    v_pk_fma_f32 v[138:139], v[64:65], v[188:189], v[138:139] op_sel:[1,0,0] op_sel_hi:[1,1,1] neg_lo:[1,0,0] neg_hi:[1,0,0]
    v_pk_fma_f32 v[140:141], v[66:67], v[188:189], v[140:141] op_sel:[1,0,0] op_sel_hi:[1,1,1] neg_lo:[1,0,0] neg_hi:[1,0,0]
    v_pk_fma_f32 v[158:159], v[52:53], v[188:189], v[158:159] op_sel:[0,0,0] op_sel_hi:[0,1,1] neg_lo:[1,0,0] neg_hi:[1,0,0]
    v_pk_fma_f32 v[160:161], v[54:55], v[188:189], v[160:161] op_sel:[0,0,0] op_sel_hi:[0,1,1] neg_lo:[1,0,0] neg_hi:[1,0,0]
    v_pk_fma_f32 v[162:163], v[56:57], v[188:189], v[162:163] op_sel:[0,0,0] op_sel_hi:[0,1,1] neg_lo:[1,0,0] neg_hi:[1,0,0]
    v_pk_fma_f32 v[164:165], v[58:59], v[188:189], v[164:165] op_sel:[0,0,0] op_sel_hi:[0,1,1] neg_lo:[1,0,0] neg_hi:[1,0,0]
    v_pk_fma_f32 v[166:167], v[60:61], v[188:189], v[166:167] op_sel:[0,0,0] op_sel_hi:[0,1,1] neg_lo:[1,0,0] neg_hi:[1,0,0]
    v_pk_fma_f32 v[168:169], v[62:63], v[188:189], v[168:169] op_sel:[0,0,0] op_sel_hi:[0,1,1] neg_lo:[1,0,0] neg_hi:[1,0,0]
    v_pk_fma_f32 v[170:171], v[64:65], v[188:189], v[170:171] op_sel:[0,0,0] op_sel_hi:[0,1,1] neg_lo:[1,0,0] neg_hi:[1,0,0]
    v_pk_fma_f32 v[172:173], v[66:67], v[188:189], v[172:173] op_sel:[0,0,0] op_sel_hi:[0,1,1] neg_lo:[1,0,0] neg_hi:[1,0,0]
    v_pk_fma_f32 v[158:159], v[52:53], v[108:109], v[158:159] op_sel:[1,0,0] op_sel_hi:[1,1,1] neg_lo:[1,0,0] neg_hi:[1,0,0]
    v_pk_fma_f32 v[160:161], v[54:55], v[108:109], v[160:161] op_sel:[1,0,0] op_sel_hi:[1,1,1] neg_lo:[1,0,0] neg_hi:[1,0,0]
    v_pk_fma_f32 v[162:163], v[56:57], v[108:109], v[162:163] op_sel:[1,0,0] op_sel_hi:[1,1,1] neg_lo:[1,0,0] neg_hi:[1,0,0]
    v_pk_fma_f32 v[164:165], v[58:59], v[108:109], v[164:165] op_sel:[1,0,0] op_sel_hi:[1,1,1] neg_lo:[1,0,0] neg_hi:[1,0,0]
    v_pk_fma_f32 v[166:167], v[60:61], v[108:109], v[166:167] op_sel:[1,0,0] op_sel_hi:[1,1,1] neg_lo:[1,0,0] neg_hi:[1,0,0]
    v_pk_fma_f32 v[168:169], v[62:63], v[108:109], v[168:169] op_sel:[1,0,0] op_sel_hi:[1,1,1] neg_lo:[1,0,0] neg_hi:[1,0,0]
    v_pk_fma_f32 v[170:171], v[64:65], v[108:109], v[170:171] op_sel:[1,0,0] op_sel_hi:[1,1,1] neg_lo:[1,0,0] neg_hi:[1,0,0]
    v_pk_fma_f32 v[172:173], v[66:67], v[108:109], v[172:173] op_sel:[1,0,0] op_sel_hi:[1,1,1] neg_lo:[1,0,0] neg_hi:[1,0,0]
    v_cvt_pk_bf16_f32 v10, v110, v111
    v_cvt_pk_bf16_f32 v11, v112, v113
    v_cvt_pk_bf16_f32 v12, v114, v115
    v_cvt_pk_bf16_f32 v13, v116, v117
    v_cvt_pk_bf16_f32 v14, v118, v119
    v_cvt_pk_bf16_f32 v15, v120, v121
    v_cvt_pk_bf16_f32 v16, v122, v123
    v_cvt_pk_bf16_f32 v17, v124, v125
    v_mfma_f32_32x32x16_bf16 v[110:125], v[10:13], v[38:41], 0
    v_cvt_pk_bf16_f32 v68, v142, v143
    v_cvt_pk_bf16_f32 v69, v144, v145
    v_cvt_pk_bf16_f32 v70, v146, v147
    v_cvt_pk_bf16_f32 v71, v148, v149
    v_cvt_pk_bf16_f32 v72, v150, v151
    v_cvt_pk_bf16_f32 v73, v152, v153
    v_mfma_f32_32x32x16_bf16 v[110:125], v[14:17], v[42:45], v[110:125]
    v_cvt_pk_bf16_f32 v74, v154, v155
    v_cvt_pk_bf16_f32 v75, v156, v157
    v_cvt_pk_bf16_f32 v214, v126, v127
    v_cvt_pk_bf16_f32 v215, v128, v129
    v_cvt_pk_bf16_f32 v216, v130, v131
    v_cvt_pk_bf16_f32 v217, v132, v133
    v_cvt_pk_bf16_f32 v218, v134, v135
    v_cvt_pk_bf16_f32 v219, v136, v137
    v_cvt_pk_bf16_f32 v220, v138, v139
    v_cvt_pk_bf16_f32 v221, v140, v141
    v_mfma_f32_32x32x16_bf16 v[142:157], v[68:71], v[38:41], 0
    v_cvt_pk_bf16_f32 v222, v158, v159
    v_cvt_pk_bf16_f32 v223, v160, v161
    v_cvt_pk_bf16_f32 v224, v162, v163
    v_cvt_pk_bf16_f32 v225, v164, v165
    v_cvt_pk_bf16_f32 v226, v166, v167
    v_cvt_pk_bf16_f32 v227, v168, v169
    v_cvt_pk_bf16_f32 v228, v170, v171
    v_cvt_pk_bf16_f32 v229, v172, v173
    v_cvt_pk_bf16_f32 v10, v110, v111
    v_cvt_pk_bf16_f32 v11, v112, v113
    v_cvt_pk_bf16_f32 v12, v114, v115
    v_mfma_f32_32x32x16_bf16 v[142:157], v[72:75], v[42:45], v[142:157]
    v_cvt_pk_bf16_f32 v13, v116, v117
    v_cvt_pk_bf16_f32 v14, v118, v119
    v_cvt_pk_bf16_f32 v15, v120, v121
    v_cvt_pk_bf16_f32 v16, v122, v123
    v_cvt_pk_bf16_f32 v17, v124, v125
    v_and_or_b32 v10, v10, -2, s30
    v_and_or_b32 v11, v11, -2, s31
    v_and_or_b32 v12, v12, -2, s30
    v_and_or_b32 v13, v13, -2, s31
    v_and_or_b32 v14, v14, -2, s30
    v_and_or_b32 v15, v15, -2, s31
    v_and_or_b32 v16, v16, -2, s30
    v_and_or_b32 v17, v17, -2, s31
    buffer_store_dwordx4 v[10:13], v6, s[64:67], s22 offen offset:0 sc1
    buffer_store_dwordx4 v[14:17], v6, s[64:67], s22 offen offset:1024 sc1
    v_mfma_f32_32x32x16_bf16 v[126:141], v[214:217], v[38:41], 0
    v_mfma_f32_32x32x16_bf16 v[126:141], v[218:221], v[42:45], v[126:141]
    v_cvt_pk_bf16_f32 v68, v142, v143
    v_cvt_pk_bf16_f32 v69, v144, v145
    v_cvt_pk_bf16_f32 v70, v146, v147
    v_cvt_pk_bf16_f32 v71, v148, v149
    v_cvt_pk_bf16_f32 v72, v150, v151
    v_cvt_pk_bf16_f32 v73, v152, v153
    v_cvt_pk_bf16_f32 v74, v154, v155
    v_cvt_pk_bf16_f32 v75, v156, v157
    v_and_or_b32 v68, v68, -2, s30
    v_and_or_b32 v69, v69, -2, s31
    v_and_or_b32 v70, v70, -2, s30
    v_and_or_b32 v71, v71, -2, s31
    v_and_or_b32 v72, v72, -2, s30
    v_and_or_b32 v73, v73, -2, s31
    v_and_or_b32 v74, v74, -2, s30
    v_and_or_b32 v75, v75, -2, s31
    buffer_store_dwordx4 v[68:71], v18, s[64:67], s22 offen offset:0 sc1
    buffer_store_dwordx4 v[72:75], v18, s[64:67], s22 offen offset:1024 sc1
    v_mfma_f32_32x32x16_bf16 v[158:173], v[222:225], v[38:41], 0
    v_mfma_f32_32x32x16_bf16 v[158:173], v[226:229], v[42:45], v[158:173]
    v_cvt_pk_bf16_f32 v214, v126, v127
    v_cvt_pk_bf16_f32 v215, v128, v129
    v_cvt_pk_bf16_f32 v216, v130, v131
    v_cvt_pk_bf16_f32 v217, v132, v133
    v_cvt_pk_bf16_f32 v218, v134, v135
    v_cvt_pk_bf16_f32 v219, v136, v137
    v_cvt_pk_bf16_f32 v220, v138, v139
    v_cvt_pk_bf16_f32 v221, v140, v141
    v_and_or_b32 v214, v214, -2, s30
    v_and_or_b32 v215, v215, -2, s31
    v_and_or_b32 v216, v216, -2, s30
    v_and_or_b32 v217, v217, -2, s31
    v_and_or_b32 v218, v218, -2, s30
    v_and_or_b32 v219, v219, -2, s31
    v_and_or_b32 v220, v220, -2, s30
    v_and_or_b32 v221, v221, -2, s31
    buffer_store_dwordx4 v[214:217], v6, s[64:67], s23 offen offset:0 sc1
    buffer_store_dwordx4 v[218:221], v6, s[64:67], s23 offen offset:1024 sc1
    v_cvt_pk_bf16_f32 v222, v158, v159
    v_cvt_pk_bf16_f32 v223, v160, v161
    v_cvt_pk_bf16_f32 v224, v162, v163
    v_cvt_pk_bf16_f32 v225, v164, v165
    v_cvt_pk_bf16_f32 v226, v166, v167
    v_cvt_pk_bf16_f32 v227, v168, v169
    v_cvt_pk_bf16_f32 v228, v170, v171
    v_cvt_pk_bf16_f32 v229, v172, v173
    v_and_or_b32 v222, v222, -2, s30
    v_and_or_b32 v223, v223, -2, s31
    v_and_or_b32 v224, v224, -2, s30
    v_and_or_b32 v225, v225, -2, s31
    v_and_or_b32 v226, v226, -2, s30
    v_and_or_b32 v227, v227, -2, s31
    v_and_or_b32 v228, v228, -2, s30
    v_and_or_b32 v229, v229, -2, s31
    buffer_store_dwordx4 v[222:225], v18, s[64:67], s23 offen offset:0 sc1
    buffer_store_dwordx4 v[226:229], v18, s[64:67], s23 offen offset:1024 sc1
    s_setprio 0
    v_and_b32 v2, 16, v0
    v_lshrrev_b32 v2, 1, v2
    v_add_u32 v2, v2, v8
    s_lshl_b32 s85, s80, 5
    s_add_u32 s85, s85, s76
    s_lshl_b32 s85, s85, 1
    s_add_u32 s85, s85, 32
    v_add_u32 v2, s85, v2
    v_lshlrev_b32 v28, 6, v2
    v_and_b32 v3, 15, v0
    s_lshl_b32 s85, s81, 7
    v_lshl_add_u32 v3, v3, 3, s85
    v_lshl_add_u32 v2, v2, 10, v3
    v_add_u32 v4, 16384, v2
    v_lshlrev_b32_e64 v25, 1, v2
    global_load_dwordx2 v[18:19], v2, s[4:5]
    global_load_dwordx2 v[20:21], v4, s[4:5]
    global_load_dwordx2 v[26:27], v3, s[20:21]
    s_mov_b32 s79, 0x6a0000
    buffer_load_dword v34, v28, s[64:67], s79 offen offset:0 sc1
    buffer_load_dword v35, v28, s[64:67], s79 offen offset:1024 sc1
    s_mul_i32 s38, s80, 196608
    s_mul_i32 s85, s76, 24576
    s_add_u32 s38, s38, s85
    v_and_b32 v4, 16, v0
    v_mul_u32_u24 v3, 12288, v8
    v_lshl_add_u32 v3, v4, 7, v3
    v_and_b32 v33, 0x70, v6
    v_add_u32_e64 v33, v33, v3
    v_add_u32 v33, 104320, v33
    v_add_u32 v40, 98304, v6
    s_waitcnt vmcnt(0)
L_MS_g:
    v_bitop3_b32 v2, v34, v35, v48 bitop3:0x7e
    v_and_b32 v2, 0xff, v2
    v_cmp_ne_u32 vcc, 0, v2
    s_cbranch_vccnz L_MS_g_r
L_MS_g_d:
    v_lshlrev_b32 v2, 16, v26
    v_and_b32 v3, 0xffff0000, v26
    v_lshlrev_b32_e64 v4, 16, v27
    v_and_b32 v5, 0xffff0000, v27
    v_lshlrev_b32_e64 v52, 16, v18
    v_and_b32 v53, 0xffff0000, v18
    v_mul_f32 v52, v52, v2
    v_mul_f32 v53, v53, v3
    v_lshlrev_b32_e64 v54, 16, v19
    v_and_b32 v55, 0xffff0000, v19
    v_mul_f32 v54, v54, v4
    v_mul_f32 v55, v55, v5
    v_lshlrev_b32_e64 v56, 16, v20
    v_and_b32 v57, 0xffff0000, v20
    v_mul_f32 v56, v56, v2
    v_mul_f32 v57, v57, v3
    v_lshlrev_b32_e64 v58, 16, v21
    v_and_b32 v59, 0xffff0000, v21
    v_mul_f32 v58, v58, v4
    v_mul_f32 v59, v59, v5
    v_and_b32 v4, 7, v0
    v_xor_b32 v4, v4, v8
    v_lshlrev_b32_e64 v4, 4, v4
    v_lshl_add_u32 v4, v7, 8, v4
    v_add_u32 v18, s39, v4
    v_xor_b32 v19, 32, v18
    v_xor_b32_e64 v20, 64, v18
    v_xor_b32 v21, 96, v18
    v_lshrrev_b32 v4, 4, v0
    v_xor_b32 v4, v4, v0
    s_lshl_b32 s85, s76, 11
    v_lshl_add_u32 v4, v4, 4, s85
    v_add_u32 v42, 16384, v4
    v_xor_b32 v43, 64, v42
    v_add_u32 v44, 106496, v4
    v_xor_b32 v45, 64, v44
    s_mov_b64 s[68:69], s[32:33]
    s_mov_b32 s70, 0x400000
    s_mov_b32 s71, 0x20000
    s_lshl_b32 s85, s87, 15
    s_sub_u32 s85, 98304, s85
    v_add_u32 v10, s85, v29
    v_add_u32 v11, s85, v30
    v_add_u32 v12, s85, v31
    v_add_u32_e64 v13, s85, v32
L_MS_cw:
    ds_read_b32 v2, v22 offset:96
    s_waitcnt lgkmcnt(0)
    v_cmp_eq_u32 vcc, 0, v2
    s_cbranch_vccnz L_MS_cw_r
L_MS_cw_d:
    buffer_load_dwordx4 v[36:39], v33, s[64:67], s38 offen sc1
    s_waitcnt vmcnt(0)
L_MS_hp:
    v_bitop3_b32 v2, v36, v37, s30 bitop3:0xdb
    v_bitop3_b32 v3, v38, v39, s30 bitop3:0xdb
    v_or_b32 v2, v2, v3
    v_and_b32 v2, 1, v2
    v_cmp_ne_u32 vcc, 0, v2
    s_cbranch_vccnz L_MS_hp_r
L_MS_hp_d:
L_MS_g2:
    s_add_u32 s23, s38, 0
    buffer_load_dwordx4 v[14:17], v6, s[64:67], s23 offen offset:0 sc1
    buffer_load_dwordx4 v[124:127], v40, s[64:67], s23 offen offset:0 sc1
    buffer_load_dwordx4 v[128:131], v6, s[64:67], s23 offen offset:1024 sc1
    buffer_load_dwordx4 v[132:135], v40, s[64:67], s23 offen offset:1024 sc1
    buffer_load_dwordx4 v[136:139], v6, s[64:67], s23 offen offset:2048 sc1
    buffer_load_dwordx4 v[140:143], v40, s[64:67], s23 offen offset:2048 sc1
    buffer_load_dwordx4 v[144:147], v6, s[64:67], s23 offen offset:3072 sc1
    buffer_load_dwordx4 v[148:151], v40, s[64:67], s23 offen offset:3072 sc1
    s_add_u32 s23, s38, 4096
    buffer_load_dwordx4 v[152:155], v6, s[64:67], s23 offen offset:0 sc1
    buffer_load_dwordx4 v[156:159], v40, s[64:67], s23 offen offset:0 sc1
    buffer_load_dwordx4 v[160:163], v6, s[64:67], s23 offen offset:1024 sc1
    buffer_load_dwordx4 v[164:167], v40, s[64:67], s23 offen offset:1024 sc1
    ds_read_b128 v[200:203], v29 offset:16384
    ds_read_b128 v[204:207], v29 offset:20480
    ds_read_b128 v[208:211], v30 offset:16384
    ds_read_b128 v[212:215], v30 offset:20480
    ds_read_b128 v[216:219], v31 offset:16384
    ds_read_b128 v[220:223], v31 offset:20480
    buffer_load_dwordx4 v[168:171], v6, s[64:67], s23 offen offset:2048 sc1
    ds_read_b128 v[224:227], v32 offset:16384
    ds_read_b128 v[228:231], v32 offset:20480
    s_waitcnt lgkmcnt(6)
    s_waitcnt vmcnt(12)
    v_mfma_f32_32x32x16_bf16 v[60:75], v[200:203], v[14:17], 0
    v_bitop3_b32 v2, v14, v15, s30 bitop3:0xdb
    v_bitop3_b32 v3, v16, v17, s30 bitop3:0xdb
    v_or_b32 v41, v2, v3
    v_mfma_f32_32x32x16_bf16 v[92:107], v[204:207], v[14:17], 0
    buffer_load_dwordx4 v[172:175], v40, s[64:67], s23 offen offset:2048 sc1
    s_waitcnt vmcnt(12)
    v_mfma_f32_32x32x16_bf16 v[76:91], v[200:203], v[124:127], 0
    v_bitop3_b32 v2, v124, v125, s30 bitop3:0xdb
    v_bitop3_b32 v3, v126, v127, s30 bitop3:0xdb
    v_or3_b32 v41, v41, v2, v3
    v_mfma_f32_32x32x16_bf16 v[108:123], v[204:207], v[124:127], 0
    buffer_load_dwordx4 v[176:179], v6, s[64:67], s23 offen offset:3072 sc1
    ds_read_b128 v[200:203], v29 offset:32768
    ds_read_b128 v[204:207], v29 offset:36864
    s_waitcnt lgkmcnt(6)
    s_waitcnt vmcnt(12)
    v_mfma_f32_32x32x16_bf16 v[60:75], v[208:211], v[128:131], v[60:75]
    v_bitop3_b32 v2, v128, v129, s30 bitop3:0xdb
    v_bitop3_b32 v3, v130, v131, s30 bitop3:0xdb
    v_or3_b32 v41, v41, v2, v3
    v_mfma_f32_32x32x16_bf16 v[92:107], v[212:215], v[128:131], v[92:107]
    buffer_load_dwordx4 v[180:183], v40, s[64:67], s23 offen offset:3072 sc1
    s_waitcnt vmcnt(12)
    v_mfma_f32_32x32x16_bf16 v[76:91], v[208:211], v[132:135], v[76:91]
    v_bitop3_b32 v2, v132, v133, s30 bitop3:0xdb
    v_bitop3_b32 v3, v134, v135, s30 bitop3:0xdb
    v_or3_b32 v41, v41, v2, v3
    v_mfma_f32_32x32x16_bf16 v[108:123], v[212:215], v[132:135], v[108:123]
    s_add_u32 s23, s38, 12288
    buffer_load_dwordx4 v[184:187], v6, s[64:67], s23 offen offset:0 sc1
    ds_read_b128 v[208:211], v30 offset:32768
    ds_read_b128 v[212:215], v30 offset:36864
    s_waitcnt lgkmcnt(6)
    s_waitcnt vmcnt(12)
    v_mfma_f32_32x32x16_bf16 v[60:75], v[216:219], v[136:139], v[60:75]
    v_bitop3_b32 v2, v136, v137, s30 bitop3:0xdb
    v_bitop3_b32 v3, v138, v139, s30 bitop3:0xdb
    v_or3_b32 v41, v41, v2, v3
    v_mfma_f32_32x32x16_bf16 v[92:107], v[220:223], v[136:139], v[92:107]
    buffer_load_dwordx4 v[188:191], v40, s[64:67], s23 offen offset:0 sc1
    s_waitcnt vmcnt(12)
    v_mfma_f32_32x32x16_bf16 v[76:91], v[216:219], v[140:143], v[76:91]
    v_bitop3_b32 v2, v140, v141, s30 bitop3:0xdb
    v_bitop3_b32 v3, v142, v143, s30 bitop3:0xdb
    v_or3_b32 v41, v41, v2, v3
    v_mfma_f32_32x32x16_bf16 v[108:123], v[220:223], v[140:143], v[108:123]
    buffer_load_dwordx4 v[192:195], v6, s[64:67], s23 offen offset:1024 sc1
    ds_read_b128 v[216:219], v31 offset:32768
    ds_read_b128 v[220:223], v31 offset:36864
    s_waitcnt lgkmcnt(6)
    s_waitcnt vmcnt(12)
    v_mfma_f32_32x32x16_bf16 v[60:75], v[224:227], v[144:147], v[60:75]
    v_bitop3_b32 v2, v144, v145, s30 bitop3:0xdb
    v_bitop3_b32 v3, v146, v147, s30 bitop3:0xdb
    v_or3_b32 v41, v41, v2, v3
    v_mfma_f32_32x32x16_bf16 v[92:107], v[228:231], v[144:147], v[92:107]
    buffer_load_dwordx4 v[196:199], v40, s[64:67], s23 offen offset:1024 sc1
    s_waitcnt vmcnt(12)
    v_mfma_f32_32x32x16_bf16 v[76:91], v[224:227], v[148:151], v[76:91]
    v_bitop3_b32 v2, v148, v149, s30 bitop3:0xdb
    v_bitop3_b32 v3, v150, v151, s30 bitop3:0xdb
    v_or3_b32 v41, v41, v2, v3
    v_mfma_f32_32x32x16_bf16 v[108:123], v[228:231], v[148:151], v[108:123]
    buffer_load_dwordx4 v[14:17], v6, s[64:67], s23 offen offset:2048 sc1
    ds_read_b128 v[224:227], v32 offset:32768
    ds_read_b128 v[228:231], v32 offset:36864
    s_waitcnt lgkmcnt(6)
    s_waitcnt vmcnt(12)
    v_mfma_f32_32x32x16_bf16 v[60:75], v[200:203], v[152:155], v[60:75]
    v_bitop3_b32 v2, v152, v153, s30 bitop3:0xdb
    v_bitop3_b32 v3, v154, v155, s30 bitop3:0xdb
    v_or3_b32 v41, v41, v2, v3
    v_mfma_f32_32x32x16_bf16 v[92:107], v[204:207], v[152:155], v[92:107]
    buffer_load_dwordx4 v[124:127], v40, s[64:67], s23 offen offset:2048 sc1
    s_waitcnt vmcnt(12)
    v_mfma_f32_32x32x16_bf16 v[76:91], v[200:203], v[156:159], v[76:91]
    v_bitop3_b32 v2, v156, v157, s30 bitop3:0xdb
    v_bitop3_b32 v3, v158, v159, s30 bitop3:0xdb
    v_or3_b32 v41, v41, v2, v3
    v_mfma_f32_32x32x16_bf16 v[108:123], v[204:207], v[156:159], v[108:123]
    buffer_load_dwordx4 v[128:131], v6, s[64:67], s23 offen offset:3072 sc1
    ds_read_b128 v[200:203], v29 offset:0
    ds_read_b128 v[204:207], v29 offset:4096
    s_waitcnt lgkmcnt(6)
    s_waitcnt vmcnt(12)
    v_mfma_f32_32x32x16_bf16 v[60:75], v[208:211], v[160:163], v[60:75]
    v_bitop3_b32 v2, v160, v161, s30 bitop3:0xdb
    v_bitop3_b32 v3, v162, v163, s30 bitop3:0xdb
    v_or3_b32 v41, v41, v2, v3
    v_mfma_f32_32x32x16_bf16 v[92:107], v[212:215], v[160:163], v[92:107]
    buffer_load_dwordx4 v[132:135], v40, s[64:67], s23 offen offset:3072 sc1
    s_waitcnt vmcnt(12)
    v_mfma_f32_32x32x16_bf16 v[76:91], v[208:211], v[164:167], v[76:91]
    v_bitop3_b32 v2, v164, v165, s30 bitop3:0xdb
    v_bitop3_b32 v3, v166, v167, s30 bitop3:0xdb
    v_or3_b32 v41, v41, v2, v3
    v_mfma_f32_32x32x16_bf16 v[108:123], v[212:215], v[164:167], v[108:123]
    s_add_u32 s23, s38, 16384
    buffer_load_dwordx4 v[136:139], v6, s[64:67], s23 offen offset:0 sc1
    ds_read_b128 v[208:211], v30 offset:0
    ds_read_b128 v[212:215], v30 offset:4096
    s_waitcnt lgkmcnt(6)
    s_waitcnt vmcnt(12)
    v_mfma_f32_32x32x16_bf16 v[60:75], v[216:219], v[168:171], v[60:75]
    v_bitop3_b32 v2, v168, v169, s30 bitop3:0xdb
    v_bitop3_b32 v3, v170, v171, s30 bitop3:0xdb
    v_or3_b32 v41, v41, v2, v3
    v_mfma_f32_32x32x16_bf16 v[92:107], v[220:223], v[168:171], v[92:107]
    buffer_load_dwordx4 v[140:143], v40, s[64:67], s23 offen offset:0 sc1
    s_waitcnt vmcnt(12)
    v_mfma_f32_32x32x16_bf16 v[76:91], v[216:219], v[172:175], v[76:91]
    v_bitop3_b32 v2, v172, v173, s30 bitop3:0xdb
    v_bitop3_b32 v3, v174, v175, s30 bitop3:0xdb
    v_or3_b32 v41, v41, v2, v3
    v_mfma_f32_32x32x16_bf16 v[108:123], v[220:223], v[172:175], v[108:123]
    buffer_load_dwordx4 v[144:147], v6, s[64:67], s23 offen offset:1024 sc1
    ds_read_b128 v[216:219], v31 offset:0
    ds_read_b128 v[220:223], v31 offset:4096
    s_waitcnt lgkmcnt(6)
    s_waitcnt vmcnt(12)
    v_mfma_f32_32x32x16_bf16 v[60:75], v[224:227], v[176:179], v[60:75]
    v_bitop3_b32 v2, v176, v177, s30 bitop3:0xdb
    v_bitop3_b32 v3, v178, v179, s30 bitop3:0xdb
    v_or3_b32 v41, v41, v2, v3
    v_mfma_f32_32x32x16_bf16 v[92:107], v[228:231], v[176:179], v[92:107]
    buffer_load_dwordx4 v[148:151], v40, s[64:67], s23 offen offset:1024 sc1
    s_waitcnt vmcnt(12)
    v_mfma_f32_32x32x16_bf16 v[76:91], v[224:227], v[180:183], v[76:91]
    v_bitop3_b32 v2, v180, v181, s30 bitop3:0xdb
    v_bitop3_b32 v3, v182, v183, s30 bitop3:0xdb
    v_or3_b32 v41, v41, v2, v3
    v_mfma_f32_32x32x16_bf16 v[108:123], v[228:231], v[180:183], v[108:123]
    buffer_load_dwordx4 v[152:155], v6, s[64:67], s23 offen offset:2048 sc1
    ds_read_b128 v[224:227], v32 offset:0
    ds_read_b128 v[228:231], v32 offset:4096
    s_waitcnt lgkmcnt(6)
    s_waitcnt vmcnt(12)
    v_mfma_f32_32x32x16_bf16 v[60:75], v[200:203], v[184:187], v[60:75]
    v_bitop3_b32 v2, v184, v185, s30 bitop3:0xdb
    v_bitop3_b32 v3, v186, v187, s30 bitop3:0xdb
    v_or3_b32 v41, v41, v2, v3
    v_mfma_f32_32x32x16_bf16 v[92:107], v[204:207], v[184:187], v[92:107]
    buffer_load_dwordx4 v[156:159], v40, s[64:67], s23 offen offset:2048 sc1
    s_waitcnt vmcnt(12)
    v_mfma_f32_32x32x16_bf16 v[76:91], v[200:203], v[188:191], v[76:91]
    v_bitop3_b32 v2, v188, v189, s30 bitop3:0xdb
    v_bitop3_b32 v3, v190, v191, s30 bitop3:0xdb
    v_or3_b32 v41, v41, v2, v3
    v_mfma_f32_32x32x16_bf16 v[108:123], v[204:207], v[188:191], v[108:123]
    buffer_load_dwordx4 v[160:163], v6, s[64:67], s23 offen offset:3072 sc1
    ds_read_b128 v[200:203], v10 offset:0
    ds_read_b128 v[204:207], v10 offset:4096
    s_waitcnt lgkmcnt(6)
    s_waitcnt vmcnt(12)
    v_mfma_f32_32x32x16_bf16 v[60:75], v[208:211], v[192:195], v[60:75]
    v_bitop3_b32 v2, v192, v193, s30 bitop3:0xdb
    v_bitop3_b32 v3, v194, v195, s30 bitop3:0xdb
    v_or3_b32 v41, v41, v2, v3
    v_mfma_f32_32x32x16_bf16 v[92:107], v[212:215], v[192:195], v[92:107]
    buffer_load_dwordx4 v[164:167], v40, s[64:67], s23 offen offset:3072 sc1
    s_waitcnt vmcnt(12)
    v_mfma_f32_32x32x16_bf16 v[76:91], v[208:211], v[196:199], v[76:91]
    v_bitop3_b32 v2, v196, v197, s30 bitop3:0xdb
    v_bitop3_b32 v3, v198, v199, s30 bitop3:0xdb
    v_or3_b32 v41, v41, v2, v3
    v_mfma_f32_32x32x16_bf16 v[108:123], v[212:215], v[196:199], v[108:123]
    ds_read_b128 v[208:211], v11 offset:0
    ds_read_b128 v[212:215], v11 offset:4096
    s_waitcnt lgkmcnt(6)
    s_waitcnt vmcnt(11)
    v_mfma_f32_32x32x16_bf16 v[60:75], v[216:219], v[14:17], v[60:75]
    v_bitop3_b32 v2, v14, v15, s30 bitop3:0xdb
    v_bitop3_b32 v3, v16, v17, s30 bitop3:0xdb
    v_or3_b32 v41, v41, v2, v3
    v_mfma_f32_32x32x16_bf16 v[92:107], v[220:223], v[14:17], v[92:107]
    s_waitcnt vmcnt(10)
    v_mfma_f32_32x32x16_bf16 v[76:91], v[216:219], v[124:127], v[76:91]
    v_bitop3_b32 v2, v124, v125, s30 bitop3:0xdb
    v_bitop3_b32 v3, v126, v127, s30 bitop3:0xdb
    v_or3_b32 v41, v41, v2, v3
    v_mfma_f32_32x32x16_bf16 v[108:123], v[220:223], v[124:127], v[108:123]
    ds_read_b128 v[216:219], v12 offset:0
    ds_read_b128 v[220:223], v12 offset:4096
    s_waitcnt lgkmcnt(6)
    s_waitcnt vmcnt(9)
    v_mfma_f32_32x32x16_bf16 v[60:75], v[224:227], v[128:131], v[60:75]
    v_bitop3_b32 v2, v128, v129, s30 bitop3:0xdb
    v_bitop3_b32 v3, v130, v131, s30 bitop3:0xdb
    v_or3_b32 v41, v41, v2, v3
    v_mfma_f32_32x32x16_bf16 v[92:107], v[228:231], v[128:131], v[92:107]
    s_waitcnt vmcnt(8)
    v_mfma_f32_32x32x16_bf16 v[76:91], v[224:227], v[132:135], v[76:91]
    v_bitop3_b32 v2, v132, v133, s30 bitop3:0xdb
    v_bitop3_b32 v3, v134, v135, s30 bitop3:0xdb
    v_or3_b32 v41, v41, v2, v3
    v_mfma_f32_32x32x16_bf16 v[108:123], v[228:231], v[132:135], v[108:123]
    ds_read_b128 v[224:227], v13 offset:0
    ds_read_b128 v[228:231], v13 offset:4096
    s_waitcnt lgkmcnt(6)
    s_waitcnt vmcnt(7)
    v_mfma_f32_32x32x16_bf16 v[60:75], v[200:203], v[136:139], v[60:75]
    v_bitop3_b32 v2, v136, v137, s30 bitop3:0xdb
    v_bitop3_b32 v3, v138, v139, s30 bitop3:0xdb
    v_or3_b32 v41, v41, v2, v3
    v_mfma_f32_32x32x16_bf16 v[92:107], v[204:207], v[136:139], v[92:107]
    s_waitcnt vmcnt(6)
    v_mfma_f32_32x32x16_bf16 v[76:91], v[200:203], v[140:143], v[76:91]
    v_bitop3_b32 v2, v140, v141, s30 bitop3:0xdb
    v_bitop3_b32 v3, v142, v143, s30 bitop3:0xdb
    v_or3_b32 v41, v41, v2, v3
    v_mfma_f32_32x32x16_bf16 v[108:123], v[204:207], v[140:143], v[108:123]
    s_waitcnt lgkmcnt(4)
    s_waitcnt vmcnt(5)
    v_mfma_f32_32x32x16_bf16 v[60:75], v[208:211], v[144:147], v[60:75]
    v_bitop3_b32 v2, v144, v145, s30 bitop3:0xdb
    v_bitop3_b32 v3, v146, v147, s30 bitop3:0xdb
    v_or3_b32 v41, v41, v2, v3
    v_mfma_f32_32x32x16_bf16 v[92:107], v[212:215], v[144:147], v[92:107]
    s_waitcnt vmcnt(4)
    v_mfma_f32_32x32x16_bf16 v[76:91], v[208:211], v[148:151], v[76:91]
    v_bitop3_b32 v2, v148, v149, s30 bitop3:0xdb
    v_bitop3_b32 v3, v150, v151, s30 bitop3:0xdb
    v_or3_b32 v41, v41, v2, v3
    v_mfma_f32_32x32x16_bf16 v[108:123], v[212:215], v[148:151], v[108:123]
    s_waitcnt lgkmcnt(2)
    s_waitcnt vmcnt(3)
    v_mfma_f32_32x32x16_bf16 v[60:75], v[216:219], v[152:155], v[60:75]
    v_bitop3_b32 v2, v152, v153, s30 bitop3:0xdb
    v_bitop3_b32 v3, v154, v155, s30 bitop3:0xdb
    v_or3_b32 v41, v41, v2, v3
    v_mfma_f32_32x32x16_bf16 v[92:107], v[220:223], v[152:155], v[92:107]
    s_waitcnt vmcnt(2)
    v_mfma_f32_32x32x16_bf16 v[76:91], v[216:219], v[156:159], v[76:91]
    v_bitop3_b32 v2, v156, v157, s30 bitop3:0xdb
    v_bitop3_b32 v3, v158, v159, s30 bitop3:0xdb
    v_or3_b32 v41, v41, v2, v3
    v_mfma_f32_32x32x16_bf16 v[108:123], v[220:223], v[156:159], v[108:123]
    s_waitcnt lgkmcnt(0)
    s_waitcnt vmcnt(1)
    v_mfma_f32_32x32x16_bf16 v[60:75], v[224:227], v[160:163], v[60:75]
    v_bitop3_b32 v2, v160, v161, s30 bitop3:0xdb
    v_bitop3_b32 v3, v162, v163, s30 bitop3:0xdb
    v_or3_b32 v41, v41, v2, v3
    v_mfma_f32_32x32x16_bf16 v[92:107], v[228:231], v[160:163], v[92:107]
    s_waitcnt vmcnt(0)
    v_mfma_f32_32x32x16_bf16 v[76:91], v[224:227], v[164:167], v[76:91]
    v_bitop3_b32 v2, v164, v165, s30 bitop3:0xdb
    v_bitop3_b32 v3, v166, v167, s30 bitop3:0xdb
    v_or3_b32 v41, v41, v2, v3
    v_mfma_f32_32x32x16_bf16 v[108:123], v[228:231], v[164:167], v[108:123]
    v_and_b32 v41, 1, v41
    v_cmp_ne_u32 vcc, 0, v41
    s_cbranch_vccnz L_MS_g2_r
L_MS_g2_d:
    ds_write_b128 v18, v[60:63] offset:0
    ds_write_b128 v19, v[64:67] offset:0
    ds_write_b128 v20, v[68:71] offset:0
    ds_write_b128 v21, v[72:75] offset:0
    ds_write_b128 v18, v[92:95] offset:128
    ds_write_b128 v19, v[96:99] offset:128
    ds_write_b128 v20, v[100:103] offset:128
    ds_write_b128 v21, v[104:107] offset:128
    ds_write_b128 v18, v[76:79] offset:16384
    ds_write_b128 v19, v[80:83] offset:16384
    ds_write_b128 v20, v[84:87] offset:16384
    ds_write_b128 v21, v[88:91] offset:16384
    ds_write_b128 v18, v[108:111] offset:16512
    ds_write_b128 v19, v[112:115] offset:16512
    ds_write_b128 v20, v[116:119] offset:16512
    ds_write_b128 v21, v[120:123] offset:16512
    s_barrier
    s_waitcnt lgkmcnt(0)
    s_barrier
    ds_read_b128 v[14:17], v42 offset:0
    ds_read_b128 v[124:127], v42 offset:8192
    ds_read_b128 v[128:131], v42 offset:49152
    ds_read_b128 v[132:135], v42 offset:57344
    ds_read_b128 v[136:139], v44 offset:0
    ds_read_b128 v[140:143], v44 offset:16384
    ds_read_b128 v[144:147], v44 offset:32768
    ds_read_b128 v[148:151], v44 offset:49152
    ds_read_b128 v[152:155], v43 offset:1024
    ds_read_b128 v[156:159], v43 offset:9216
    ds_read_b128 v[160:163], v43 offset:50176
    ds_read_b128 v[164:167], v43 offset:58368
    ds_read_b128 v[168:171], v45 offset:1024
    ds_read_b128 v[172:175], v45 offset:17408
    ds_read_b128 v[176:179], v45 offset:33792
    ds_read_b128 v[180:183], v45 offset:50176
    s_mov_b32 s23, 32768
    s_waitcnt lgkmcnt(12)
    s_nop 0
    v_pk_add_f32 v[52:53], v[52:53], v[14:15]
    v_pk_add_f32 v[54:55], v[54:55], v[16:17]
    v_pk_add_f32 v[52:53], v[52:53], v[124:125]
    v_pk_add_f32 v[54:55], v[54:55], v[126:127]
    v_pk_add_f32 v[52:53], v[52:53], v[128:129]
    v_pk_add_f32 v[54:55], v[54:55], v[130:131]
    v_pk_add_f32 v[52:53], v[52:53], v[132:133]
    v_pk_add_f32 v[54:55], v[54:55], v[134:135]
    s_waitcnt lgkmcnt(8)
    s_nop 0
    v_pk_add_f32 v[136:137], v[136:137], v[140:141]
    v_pk_add_f32 v[138:139], v[138:139], v[142:143]
    v_pk_add_f32 v[136:137], v[136:137], v[144:145]
    v_pk_add_f32 v[138:139], v[138:139], v[146:147]
    v_pk_add_f32 v[136:137], v[136:137], v[148:149]
    v_pk_add_f32 v[138:139], v[138:139], v[150:151]
    v_pk_add_f32 v[52:53], v[52:53], v[136:137] neg_lo:[0,1] neg_hi:[0,1]
    v_pk_add_f32 v[54:55], v[54:55], v[138:139] neg_lo:[0,1] neg_hi:[0,1]
    v_pk_fma_f32 v[136:137], v[34:35], v[52:53], v[136:137] op_sel:[0,0,0] op_sel_hi:[0,1,1]
    v_pk_fma_f32 v[138:139], v[34:35], v[54:55], v[138:139] op_sel:[0,0,0] op_sel_hi:[0,1,1]
    buffer_store_dwordx4 v[136:139], v25, s[68:71], 0 offen sc1
    s_waitcnt lgkmcnt(4)
    s_nop 0
    v_pk_add_f32 v[56:57], v[56:57], v[152:153]
    v_pk_add_f32 v[58:59], v[58:59], v[154:155]
    v_pk_add_f32 v[56:57], v[56:57], v[156:157]
    v_pk_add_f32 v[58:59], v[58:59], v[158:159]
    v_pk_add_f32 v[56:57], v[56:57], v[160:161]
    v_pk_add_f32 v[58:59], v[58:59], v[162:163]
    v_pk_add_f32 v[56:57], v[56:57], v[164:165]
    v_pk_add_f32 v[58:59], v[58:59], v[166:167]
    s_waitcnt lgkmcnt(0)
    s_nop 0
    v_pk_add_f32 v[168:169], v[168:169], v[172:173]
    v_pk_add_f32 v[170:171], v[170:171], v[174:175]
    v_pk_add_f32 v[168:169], v[168:169], v[176:177]
    v_pk_add_f32 v[170:171], v[170:171], v[178:179]
    v_pk_add_f32 v[168:169], v[168:169], v[180:181]
    v_pk_add_f32 v[170:171], v[170:171], v[182:183]
    v_pk_add_f32 v[56:57], v[56:57], v[168:169] neg_lo:[0,1] neg_hi:[0,1]
    v_pk_add_f32 v[58:59], v[58:59], v[170:171] neg_lo:[0,1] neg_hi:[0,1]
    v_pk_fma_f32 v[168:169], v[34:35], v[56:57], v[168:169] op_sel:[1,0,0] op_sel_hi:[1,1,1]
    v_pk_fma_f32 v[170:171], v[34:35], v[58:59], v[170:171] op_sel:[1,0,0] op_sel_hi:[1,1,1]
    buffer_store_dwordx4 v[168:171], v25, s[68:71], s23 offen sc1
    s_endpgm
L_MS_s2_r:
    s_waitcnt lgkmcnt(0)
    s_cmp_eq_u32 s88, 0
    s_cbranch_scc1 L_MS_s2_d
    s_sub_u32 s88, s88, 1
    s_branch L_MS_s2
L_MS_e_r:
    s_cmp_eq_u32 s88, 0
    s_cbranch_scc1 L_MS_e_d
    s_sub_u32 s88, s88, 1
    buffer_load_dwordx2 v[198:199], v92, s[72:75], 0 offen sc1
    buffer_load_dwordx2 v[200:201], v93, s[72:75], 0 offen sc1
    buffer_load_dwordx2 v[202:203], v94, s[72:75], 0 offen sc1
    buffer_load_dwordx2 v[204:205], v95, s[72:75], 0 offen sc1
    buffer_load_dwordx2 v[206:207], v96, s[72:75], 0 offen sc1
    buffer_load_dwordx2 v[208:209], v97, s[72:75], 0 offen sc1
    buffer_load_dwordx2 v[210:211], v98, s[72:75], 0 offen sc1
    buffer_load_dwordx2 v[212:213], v99, s[72:75], 0 offen sc1
    s_waitcnt vmcnt(0)
    s_branch L_MS_e
L_MS_g_r:
    s_cmp_eq_u32 s88, 0
    s_cbranch_scc1 L_MS_g_d
    s_sub_u32 s88, s88, 1
    buffer_load_dword v34, v28, s[64:67], s79 offen offset:0 sc1
    buffer_load_dword v35, v28, s[64:67], s79 offen offset:1024 sc1
    s_waitcnt vmcnt(0)
    s_branch L_MS_g
L_MS_cw_r:
    s_waitcnt lgkmcnt(0)
    s_cmp_eq_u32 s88, 0
    s_cbranch_scc1 L_MS_cw_d
    s_sub_u32 s88, s88, 1
    s_sleep 2
    s_branch L_MS_cw
L_MS_hp_r:
    s_cmp_eq_u32 s88, 0
    s_cbranch_scc1 L_MS_hp_d
    s_sub_u32 s88, s88, 1
    buffer_load_dwordx4 v[36:39], v33, s[64:67], s38 offen sc1
    s_waitcnt vmcnt(0)
    s_branch L_MS_hp
L_MS_g2_r:
    s_cmp_eq_u32 s88, 0
    s_cbranch_scc1 L_MS_g2_d
    s_sub_u32 s88, s88, 1
    s_nop 15
    s_waitcnt vmcnt(0) lgkmcnt(0)
    s_branch L_MS_g2
L_end:
    s_endpgm
.section .rodata,"a"
.p2align 6
.amdhsa_kernel gated_mix__ssm_conv_s5__linear_kernel_hedgehog__prompt_kernel
  .amdhsa_next_free_vgpr 256
  .amdhsa_next_free_sgpr 102
  .amdhsa_accum_offset 256
  .amdhsa_group_segment_fixed_size 0
  .amdhsa_kernarg_size 136
  .amdhsa_user_sgpr_count 2
  .amdhsa_user_sgpr_kernarg_segment_ptr 1
  .amdhsa_system_sgpr_workgroup_id_x 1
.end_amdhsa_kernel
```
